```python
import torch

def _softmax(x, axis=-1):
    return torch.softmax(x, dim=axis)
def _gelu(x):
    return torch.nn.functional.gelu(x, approximate="tanh")
def _silu(x):
    return torch.nn.functional.silu(x)
def _sigmoid(x):
    return torch.sigmoid(x)
def _layernorm(x, axis=-1, eps=1e-5):
    m = x.mean(dim=axis, keepdim=True)
    v = x.var(dim=axis, keepdim=True, unbiased=False)
    return (x - m) / torch.sqrt(v + eps)
def _scatter_add(tgt, idx, src, axis=0):
    return tgt.clone().index_add_(axis, idx, src)
def _segment_sum(src, seg, n):
    out = torch.zeros((n,) + src.shape[1:], dtype=src.dtype)
    return out.index_add_(0, seg, src)
def _pad(x, pw):
    flat = tuple(v for pair in reversed(pw) for v in pair)
    return torch.nn.functional.pad(x, flat)

kernel_name = 'interleave_layers__mha_block__dense_activation_relu__prompt'

def setup_inputs():

    _w = (lambda a: (lambda t: t.to(torch.bfloat16) if t.is_floating_point() else t)(torch.as_tensor(a)))
    def _A_setup():
        B, S, D, H = 1, 2048, 448, 16
        return {
            "x": _w((lambda *s: torch.randn(*s, dtype=torch.bfloat16) * 0.05)(B, S, D)),
            "wqkv": _w((lambda *s: torch.randn(*s, dtype=torch.bfloat16) * 0.05)(D, 3 * D)),
            "wo": _w((lambda *s: torch.randn(*s, dtype=torch.bfloat16) * 0.05)(D, D)),
        }
    _A_in = _A_setup()

    def _B_setup():
        B, S, D, Dff = 1, 2048, 448, 1792
        return {
            "x": _w((lambda *s: torch.randn(*s, dtype=torch.bfloat16) * 0.05)(B, S, D)),
            "w1": _w((lambda *s: torch.randn(*s, dtype=torch.bfloat16) * 0.05)(D, Dff)),
            "w2": _w((lambda *s: torch.randn(*s, dtype=torch.bfloat16) * 0.05)(Dff, D)),
        }
    _B_in = _B_setup()

    return {
        "A_x": _A_in["x"],
        "A_wqkv": _A_in["wqkv"],
        "A_wo": _A_in["wo"],
        "B_x": _B_in["x"],
        "B_w1": _B_in["w1"],
        "B_w2": _B_in["w2"],
    }

def reference(A_x, A_wqkv, A_wo, B_x, B_w1, B_w2):
    def _A_ref(x, wqkv, wo):
        B, S, D = x.shape
        H = 16
        Dh = D // H
        qkv = (lambda x, *d: x.permute(*d))((x @ wqkv).reshape(B, S, 3, H, Dh), 2, 0, 3, 1, 4)
        q, k, v = qkv[0], qkv[1], qkv[2]
        scores = torch.einsum("bhqd,bhkd->bhqk", q, k) * (Dh ** -0.5)
        p = _softmax(scores, axis=-1)
        o = torch.einsum("bhqk,bhkd->bhqd", p, v)
        return (lambda x, *d: x.permute(*d))(o, 0, 2, 1, 3).reshape(B, S, D) @ wo

    def _B_ref(x, w1, w2):
        h = torch.einsum("bsd,df->bsf", x, w1)
        zero = torch.zeros_like(h)
        h = torch.maximum(h, zero)
        return torch.einsum("bsf,fd->bsd", h, w2)

    x = A_x
    x = x + _A_ref(_layernorm(x, axis=-1), A_wqkv, A_wo)
    x = x + _B_ref(_layernorm(x, axis=-1), B_w1, B_w2)
    x = x + _A_ref(_layernorm(x, axis=-1), A_wqkv, A_wo)
    x = x + _B_ref(_layernorm(x, axis=-1), B_w1, B_w2)
    return x
```

```asm
; @launch grid=(256,1,1) block=(256,1,1) lds=163840
.amdgcn_target "amdgcn-amd-amdhsa--gfx950"
.text
.globl interleave_layers__mha_block__dense_activation_relu__prompt_kernel
.p2align 8
.type interleave_layers__mha_block__dense_activation_relu__prompt_kernel,@function
interleave_layers__mha_block__dense_activation_relu__prompt_kernel:
    s_cmp_ge_u32 s2, 256
    s_cbranch_scc1 L_end
    s_load_dwordx16 s[48:63], s[0:1], 0
    s_load_dwordx2 s[4:5], s[0:1], 64
    s_memrealtime s[42:43]
    v_lshrrev_b32 v3, 6, v0
    v_and_b32 v1, 63, v0
    s_mov_b32 s6, 27262976
    v_readfirstlane_b32 s3, v3
    s_mov_b32 s7, 0x20000
    v_lshlrev_b32 v2, 4, v1
    s_lshr_b32 s9, s2, 3
    s_lshr_b32 s8, s9, 4
    s_and_b32 s9, s9, 15
    s_and_b32 s10, s2, 7
    s_lshl_b32 s10, s10, 1
    s_add_u32 s8, s8, s10
    s_lshl_b32 s10, s8, 2
    s_add_u32 s10, s10, s3
    s_lshr_b32 s13, s2, 3
    s_and_b32 s14, s2, 7
    s_lshr_b32 s29, s14, 3
    s_lshl_b32 s29, s29, 4
    s_and_b32 s12, s13, 15
    s_add_u32 s29, s29, s12
    s_and_b32 s28, s14, 7
    s_lshl_b32 s28, s28, 1
    s_lshr_b32 s12, s13, 4
    s_add_u32 s28, s28, s12
    s_lshl_b32 s30, s28, 2
    s_add_u32 s30, s30, s3
    v_lshrrev_b32 v14, 2, v1
    v_and_b32 v15, 3, v1
    v_mul_u32_u24 v240, 2688, v14
    v_lshl_add_u32 v240, v15, 4, v240
    v_lshrrev_b32 v12, 3, v1
    v_and_b32 v13, 7, v1
    v_xor_b32 v13, v13, v12
    v_mul_u32_u24 v241, 896, v12
    v_lshl_add_u32 v241, v13, 4, v241
    s_mul_i32 s11, s30, 28672
    s_mul_i32 s40, s3, 43008
    s_mul_i32 s12, s29, 56
    s_and_b32 s12, s12, -1
    s_add_u32 s40, s40, s12
    s_lshl_b32 s41, s3, 10
    s_mul_i32 s26, s3, 19456
    s_add_u32 s26, s26, 86016
    s_mov_b32 s38, 1835008
    s_mov_b32 s39, 0x20000
    s_mov_b32 s46, 1204224
    s_mov_b32 s47, 0x20000
    s_waitcnt lgkmcnt(0)
    s_mov_b32 s36, s48
    s_mov_b32 s37, s49
    s_mov_b32 s44, s50
    s_mov_b32 s45, s51
    s_mov_b32 s54, s28
    s_mov_b32 s55, s29
    s_mov_b32 s0, s30
    v_lshlrev_b32 v12, 7, v1
    s_and_b32 s15, s55, 15
    s_mul_i32 s15, s15, 1792
    s_add_u32 s15, s15, s11
    s_mov_b32 exec_lo, 0x3fff
    s_mov_b32 exec_hi, 0x0
    buffer_load_dword v25, v12, s[36:39], s15 offen
    s_mov_b64 exec, -1
    s_add_u32 m0, s41, 0
    s_add_u32 s19, s40, 896
    buffer_load_dwordx4 v240, s[44:47], s19 offen lds
    s_add_u32 m0, s41, 28672
    s_add_u32 s19, s40, 1792
    buffer_load_dwordx4 v240, s[44:47], s19 offen lds
    s_add_u32 m0, s26, 0
    s_add_u32 s19, s11, 0
    buffer_load_dwordx4 v241, s[36:39], s19 offen offset:0 lds
    s_add_u32 s19, s11, 6016
    buffer_load_dwordx4 v241, s[36:39], s19 offen offset:1152 lds
    s_add_u32 s19, s11, 12032
    buffer_load_dwordx4 v241, s[36:39], s19 offen offset:2304 lds
    s_add_u32 s19, s11, 18048
    buffer_load_dwordx4 v241, s[36:39], s19 offen offset:3456 lds
    s_lshr_b32 s12, s2, 3
    s_lshl_b32 s12, s12, 2
    s_add_u32 s12, s12, s3
    s_mul_i32 s12, s12, 8064
    s_add_u32 s12, s12, 172032
    s_mov_b32 exec_lo, 0xffffffff
    s_mov_b32 exec_hi, 0x7fffffff
    buffer_load_dword v26, v12, s[44:47], s12 offen
    s_cbranch_execz L_walk
    s_mov_b64 exec, -1
    s_add_u32 m0, s41, 4096
    s_add_u32 s19, s40, 172928
    buffer_load_dwordx4 v240, s[44:47], s19 offen lds
    s_add_u32 m0, s41, 32768
    s_add_u32 s19, s40, 173824
    buffer_load_dwordx4 v240, s[44:47], s19 offen lds
    s_add_u32 m0, s26, 4608
    s_add_u32 s19, s11, 128
    buffer_load_dwordx4 v241, s[36:39], s19 offen offset:0 lds
    s_add_u32 s19, s11, 6144
    buffer_load_dwordx4 v241, s[36:39], s19 offen offset:1152 lds
    s_add_u32 s19, s11, 12160
    buffer_load_dwordx4 v241, s[36:39], s19 offen offset:2304 lds
    s_add_u32 s19, s11, 18176
    buffer_load_dwordx4 v241, s[36:39], s19 offen offset:3456 lds
    s_lshr_b32 s12, s2, 3
    s_lshl_b32 s12, s12, 2
    s_add_u32 s12, s12, s3
    s_mul_i32 s12, s12, 512
    s_add_u32 s12, s12, 512
    s_mov_b64 exec, 0
L_walk:
    s_cmp_ge_u32 s12, 36272
    s_cbranch_scc1 L_walkd
    s_getpc_b64 s[14:15]
L_walkpc:
    s_sub_u32 s14, s14, L_walkpc-interleave_layers__mha_block__dense_activation_relu__prompt_kernel
    s_subb_u32 s15, s15, 0
    s_add_u32 s14, s14, s12
    s_addc_u32 s15, s15, 0
    s_add_u32 s12, s12, 65536
    s_setpc_b64 s[14:15]
L_walkd:
    s_mov_b64 exec, -1
    v_lshrrev_b32 v5, 5, v1
    v_and_b32 v12, 7, v14
    v_mul_u32_u24 v216, 896, v12
    v_lshl_add_u32 v216, v5, 6, v216
    v_lshl_add_u32 v216, v15, 4, v216
    s_min_u32 s34, s9, 13
    s_cmp_ge_u32 s34, 7
    s_cselect_b32 s12, 7, 0
    s_sub_u32 s33, s34, s12
    s_or_b32 s24, s2, s3
    s_cmp_lg_u32 s24, 0
    s_cbranch_scc1 L_notag
    s_and_b32 s42, s42, 0xfffffff0
    s_bitset1_b32 s43, 31
    v_mov_b32 v214, s42
    v_mov_b32 v215, s43
    s_mov_b32 s12, s62
    s_mov_b32 s13, s63
    s_mov_b32 s14, 256
    s_mov_b32 s15, 0x20000
    s_mov_b64 exec, 1
    buffer_store_dwordx2 v[214:215], off, s[12:15], 0 sc0 sc1
    s_mov_b64 exec, -1
L_notag:
    s_add_u32 m0, s41, 8192
    s_add_u32 s19, s40, 344960
    buffer_load_dwordx4 v240, s[44:47], s19 offen lds
    s_cmp_ge_u32 s34, 7
    s_cselect_b32 s13, 2, 0
    s_and_b32 s14, s3, 1
    s_add_u32 s14, s14, s13
    s_add_u32 m0, s41, 36864
    s_add_u32 s19, s40, 345856
    buffer_load_dwordx4 v240, s[44:47], s19 offen lds
    s_lshl_b32 s28, s8, 2
    s_add_u32 s28, s28, s14
    s_lshr_b32 s15, s3, 1
    s_lshl_b32 s29, s33, 1
    s_add_u32 s29, s29, s15
    s_lshl_b32 s17, s3, 7
    s_lshl_b32 s16, s9, 3
    s_add_u32 s17, s17, s16
    s_lshl_b32 s18, s14, 7
    s_lshl_b32 s16, s29, 3
    s_add_u32 s18, s18, s16
    s_lshl_b32 s15, s15, 10
    v_add_u32 v6, s15, v2
    v_xor_b32 v7, 0x400, v6
    s_add_u32 m0, s26, 9216
    s_add_u32 s19, s11, 256
    buffer_load_dwordx4 v241, s[36:39], s19 offen offset:0 lds
    v_lshlrev_b32 v4, 2, v1
    v_and_b32 v0, 15, v1
    v_min_u32 v0, 13, v0
    v_lshlrev_b32 v0, 3, v0
    s_lshl_b32 s16, s3, 7
    v_add_u32 v0, s16, v0
    v_and_b32 v3, 1, v14
    v_add_u32 v3, s13, v3
    v_lshlrev_b32 v3, 7, v3
    s_cbranch_execz L_walk
    v_lshl_add_u32 v3, v15, 3, v3
    s_mul_i32 s16, s3, 7
    s_lshr_b32 s16, s16, 1
    s_lshl_b32 s16, s16, 3
    v_add_u32 v212, s16, v3
    s_add_u32 m0, s26, 9216
    s_add_u32 s19, s11, 6272
    buffer_load_dwordx4 v241, s[36:39], s19 offen offset:1152 lds
    s_lshl_b32 s16, s3, 5
    v_add_u32 v3, s16, v3
    s_mov_b32 s30, 0
    s_mov_b32 s31, 16777216
    s_lshl_b32 s32, s8, 12
    s_add_u32 s32, s32, 2654208
    s_lshl_b32 s1, s54, 12
    s_add_u32 s1, s1, 2654208
    s_mov_b32 s20, -1
    s_mov_b32 s21, 0
    s_mov_b32 s22, 0xf0000000
    s_mov_b32 s23, 0xf0000000
    v_and_b32 v12, 7, v14
    v_mul_u32_u24 v211, 3584, v12
    s_add_u32 m0, s26, 9216
    s_add_u32 s19, s11, 12288
    buffer_load_dwordx4 v241, s[36:39], s19 offen offset:2304 lds
    v_lshl_add_u32 v211, v5, 6, v211
    v_lshl_add_u32 v211, v15, 4, v211
    v_and_b32 v12, 3, v14
    v_lshlrev_b32 v12, 6, v12
    v_bfe_u32 v14, v1, 4, 1
    v_lshl_add_u32 v12, v14, 5, v12
    v_lshl_add_u32 v12, v15, 3, v12
    v_lshl_add_u32 v208, v5, 9, v12
    v_add_u32 v209, 256, v208
    v_lshl_add_u32 v213, v5, 8, v12
    v_bfe_u32 v12, v1, 3, 2
    v_mul_u32_u24 v12, 1152, v12
    v_and_b32 v13, 7, v1
    v_lshl_add_u32 v12, v13, 7, v12
    s_add_u32 m0, s26, 9216
    s_add_u32 s19, s11, 18304
    buffer_load_dwordx4 v241, s[36:39], s19 offen offset:3456 lds
    v_xor_b32 v13, v13, v5
    v_lshl_add_u32 v12, v13, 4, v12
    v_add_u32 v242, s26, v12
    v_xor_b32 v243, 32, v242
    v_xor_b32 v244, 64, v242
    v_xor_b32 v245, 0x60, v242
    s_lshl_b32 s12, s55, 6
    s_add_u32 s12, s12, s0
    s_lshl_b32 s64, s12, 12
    s_lshl_b32 s12, s0, 15
    s_lshl_b32 s13, s55, 11
    s_add_u32 s12, s12, s13
    s_add_u32 s65, s12, 7340032
    s_mul_i32 s12, s28, 28672
    s_add_u32 m0, s41, 12288
    s_add_u32 s19, s40, 516992
    buffer_load_dwordx4 v240, s[44:47], s19 offen lds
    s_lshl_b32 s13, s29, 11
    s_add_u32 s66, s12, s13
    s_lshl_b32 s12, s28, 12
    s_lshl_b32 s13, s29, 8
    s_add_u32 s67, s12, s13
    s_mul_i32 s12, s10, 114688
    s_lshl_b32 s13, s34, 12
    s_add_u32 s12, s12, s13
    s_add_u32 s68, s12, 9437184
    s_lshl_b32 s13, s3, 13
    s_add_u32 s13, s13, 7340032
    s_lshl_b32 s12, s28, 15
    s_add_u32 s69, s12, s13
    s_xor_b32 s12, s12, 0x8000
    s_add_u32 m0, s41, 40960
    s_add_u32 s19, s40, 517888
    buffer_load_dwordx4 v240, s[44:47], s19 offen lds
    s_add_u32 s70, s12, s13
    s_mul_i32 s13, s3, 14336
    s_add_u32 s13, s13, 9437184
    s_mul_i32 s12, s28, 114688
    s_add_u32 s71, s12, s13
    s_xor_b32 s12, s28, 1
    s_nop 0
    s_cbranch_execz L_walk
    s_mul_i32 s12, s12, 114688
    s_add_u32 s72, s12, s13
    s_lshl_b32 s12, s33, 16
    s_lshl_b32 s13, s3, 14
    s_add_u32 s12, s12, s13
    s_add_u32 s73, s12, 1638400
    s_mul_i32 s12, s33, 229376
    s_mul_i32 s13, s3, 28672
    s_add_u32 m0, s26, 13824
    s_add_u32 s19, s11, 384
    buffer_load_dwordx4 v241, s[36:39], s19 offen offset:0 lds
    s_add_u32 s12, s12, s13
    s_add_u32 s74, s12, 0
    s_lshl_b32 s12, s34, 7
    s_mul_i32 s13, s3, 401408
    s_add_u32 s75, s12, s13
    s_lshl_b32 s76, s3, 7
    s_lshl_b32 s12, s55, 3
    s_add_u32 s76, s76, s12
    s_mul_i32 s12, s55, 86016
    s_add_u32 s77, s12, 25165824
    s_lshl_b32 s12, s55, 18
    s_lshl_b32 s13, s3, 12
    s_add_u32 s78, s12, s13
    s_lshl_b32 s13, s3, 7
    s_add_u32 m0, s26, 13824
    s_add_u32 s19, s11, 6400
    buffer_load_dwordx4 v241, s[36:39], s19 offen offset:1152 lds
    s_add_u32 s13, s13, s32
    v_mov_b32 v210, s13
    v_and_b32 v12, 15, v1
    v_lshlrev_b32 v12, 7, v12
    v_lshlrev_b32 v12, 2, v12
    s_sub_u32 s12, s13, 1024
    v_add_u32 v13, s12, v12
    s_mov_b32 vcc_lo, 0
    s_mov_b32 vcc_hi, 0x01fc0000
    v_cndmask_b32 v210, v210, v13, vcc
    s_add_u32 s12, s13, 60928
    v_add_u32 v13, s12, v12
    s_mov_b32 vcc_hi, 0xfe000000
    v_cndmask_b32 v210, v210, v13, vcc
    s_add_u32 m0, s26, 13824
    s_add_u32 s19, s11, 12416
    buffer_load_dwordx4 v241, s[36:39], s19 offen offset:2304 lds
    s_xor_b32 s25, s3, 1
    s_mul_i32 s25, s25, 12288
    s_add_u32 s25, s25, 114688
    v_add_u32 v9, s25, v2
    s_xor_b32 s25, s3, 2
    s_mul_i32 s25, s25, 12288
    s_add_u32 s25, s25, 118784
    v_add_u32 v10, s25, v2
    s_xor_b32 s25, s3, 3
    s_mul_i32 s25, s25, 12288
    s_add_u32 s25, s25, 122880
    v_add_u32 v11, s25, v2
    s_mul_i32 s25, s3, 12288
    s_add_u32 s25, s25, 114688
    s_add_u32 m0, s26, 13824
    s_add_u32 s19, s11, 18432
    buffer_load_dwordx4 v241, s[36:39], s19 offen offset:3456 lds
    v_add_u32 v8, s25, v2
    s_mov_b32 s35, 1
    s_lshl_b32 s16, s3, 10
    v_add_u32 v246, s16, v208
    v_add_u32 v247, s16, v209
    v_add_u32 v248, 57344, v246
    v_add_u32 v249, 57344, v247
    v_mov_b32 v88, 0x3f803f80
    v_and_b32 v13, 31, v1
    v_mul_u32_u24 v13, 896, v13
    v_lshl_add_u32 v13, v5, 4, v13
    v_mov_b32 v80, 0
    v_mov_b32 v81, 0
    v_mov_b32 v82, 0
    v_mov_b32 v83, 0
    v_mov_b32 v84, 0
    v_mov_b32 v85, 0
    v_mov_b32 v86, 0
    v_mov_b32 v87, 0
    s_waitcnt vmcnt(19)
    ds_read_b128 v[96:99], v242 offset:0
    ds_read_b128 v[100:103], v243 offset:0
    ds_read_b128 v[104:107], v244 offset:0
    ds_read_b128 v[108:111], v245 offset:0
    s_nop 0
    s_cbranch_execz L_walk
    ds_read_b64_tr_b16 v[64:65], v246 offset:0
    ds_read_b64_tr_b16 v[66:67], v247 offset:0
    ds_read_b64_tr_b16 v[68:69], v246 offset:28672
    ds_read_b64_tr_b16 v[70:71], v247 offset:28672
    s_add_u32 m0, s41, 16384
    s_add_u32 s19, s40, 689024
    buffer_load_dwordx4 v240, s[44:47], s19 offen lds
    s_add_u32 m0, s41, 45056
    s_add_u32 s19, s40, 689920
    buffer_load_dwordx4 v240, s[44:47], s19 offen lds
    s_waitcnt lgkmcnt(4)
    s_add_u32 m0, s26, 0
    s_add_u32 s19, s11, 512
    buffer_load_dwordx4 v241, s[36:39], s19 offen offset:0 lds
    s_add_u32 s19, s11, 6528
    buffer_load_dwordx4 v241, s[36:39], s19 offen offset:1152 lds
    s_add_u32 s19, s11, 12544
    buffer_load_dwordx4 v241, s[36:39], s19 offen offset:2304 lds
    s_add_u32 s19, s11, 18560
    buffer_load_dwordx4 v241, s[36:39], s19 offen offset:3456 lds
    v_dot2c_f32_bf16 v80, v96, v88
    v_dot2c_f32_bf16 v82, v96, v96
    v_dot2c_f32_bf16 v81, v97, v88
    v_dot2c_f32_bf16 v83, v97, v97
    v_dot2c_f32_bf16 v80, v98, v88
    v_dot2c_f32_bf16 v82, v98, v98
    v_dot2c_f32_bf16 v81, v99, v88
    v_dot2c_f32_bf16 v83, v99, v99
    v_dot2c_f32_bf16 v80, v100, v88
    v_dot2c_f32_bf16 v82, v100, v100
    v_dot2c_f32_bf16 v81, v101, v88
    v_dot2c_f32_bf16 v83, v101, v101
    v_dot2c_f32_bf16 v80, v102, v88
    v_dot2c_f32_bf16 v82, v102, v102
    v_dot2c_f32_bf16 v81, v103, v88
    v_dot2c_f32_bf16 v83, v103, v103
    v_dot2c_f32_bf16 v80, v104, v88
    v_dot2c_f32_bf16 v82, v104, v104
    v_dot2c_f32_bf16 v81, v105, v88
    v_dot2c_f32_bf16 v83, v105, v105
    v_dot2c_f32_bf16 v80, v106, v88
    v_dot2c_f32_bf16 v82, v106, v106
    v_dot2c_f32_bf16 v81, v107, v88
    v_dot2c_f32_bf16 v83, v107, v107
    v_dot2c_f32_bf16 v80, v108, v88
    v_dot2c_f32_bf16 v82, v108, v108
    v_dot2c_f32_bf16 v81, v109, v88
    v_dot2c_f32_bf16 v83, v109, v109
    v_dot2c_f32_bf16 v80, v110, v88
    v_dot2c_f32_bf16 v82, v110, v110
    v_dot2c_f32_bf16 v81, v111, v88
    v_dot2c_f32_bf16 v83, v111, v111
    s_waitcnt lgkmcnt(0)
    v_dot2c_f32_bf16 v84, v64, v88
    v_dot2c_f32_bf16 v85, v68, v88
    v_dot2c_f32_bf16 v84, v65, v88
    v_dot2c_f32_bf16 v85, v69, v88
    v_dot2c_f32_bf16 v84, v66, v88
    v_dot2c_f32_bf16 v85, v70, v88
    v_dot2c_f32_bf16 v84, v67, v88
    v_dot2c_f32_bf16 v85, v71, v88
    s_waitcnt vmcnt(18)
    ds_read_b128 v[112:115], v242 offset:4608
    ds_read_b128 v[116:119], v243 offset:4608
    ds_read_b128 v[120:123], v244 offset:4608
    ds_read_b128 v[124:127], v245 offset:4608
    ds_read_b64_tr_b16 v[64:65], v246 offset:4096
    ds_read_b64_tr_b16 v[66:67], v247 offset:4096
    ds_read_b64_tr_b16 v[68:69], v246 offset:32768
    ds_read_b64_tr_b16 v[70:71], v247 offset:32768
    s_add_u32 m0, s41, 20480
    s_add_u32 s19, s40, 861056
    buffer_load_dwordx4 v240, s[44:47], s19 offen lds
    s_add_u32 m0, s41, 49152
    s_add_u32 s19, s40, 861952
    buffer_load_dwordx4 v240, s[44:47], s19 offen lds
    s_waitcnt lgkmcnt(4)
    s_add_u32 m0, s26, 4608
    s_add_u32 s19, s11, 640
    buffer_load_dwordx4 v241, s[36:39], s19 offen offset:0 lds
    s_add_u32 s19, s11, 6656
    buffer_load_dwordx4 v241, s[36:39], s19 offen offset:1152 lds
    s_add_u32 s19, s11, 12672
    buffer_load_dwordx4 v241, s[36:39], s19 offen offset:2304 lds
    s_add_u32 s19, s11, 18688
    buffer_load_dwordx4 v241, s[36:39], s19 offen offset:3456 lds
    s_cbranch_execz L_walk
    v_dot2c_f32_bf16 v80, v112, v88
    v_dot2c_f32_bf16 v82, v112, v112
    v_dot2c_f32_bf16 v81, v113, v88
    v_dot2c_f32_bf16 v83, v113, v113
    v_dot2c_f32_bf16 v80, v114, v88
    v_dot2c_f32_bf16 v82, v114, v114
    v_dot2c_f32_bf16 v81, v115, v88
    v_dot2c_f32_bf16 v83, v115, v115
    v_dot2c_f32_bf16 v80, v116, v88
    v_dot2c_f32_bf16 v82, v116, v116
    v_dot2c_f32_bf16 v81, v117, v88
    v_dot2c_f32_bf16 v83, v117, v117
    v_dot2c_f32_bf16 v80, v118, v88
    v_dot2c_f32_bf16 v82, v118, v118
    v_dot2c_f32_bf16 v81, v119, v88
    v_dot2c_f32_bf16 v83, v119, v119
    v_dot2c_f32_bf16 v80, v120, v88
    v_dot2c_f32_bf16 v82, v120, v120
    v_dot2c_f32_bf16 v81, v121, v88
    v_dot2c_f32_bf16 v83, v121, v121
    v_dot2c_f32_bf16 v80, v122, v88
    v_dot2c_f32_bf16 v82, v122, v122
    v_dot2c_f32_bf16 v81, v123, v88
    v_dot2c_f32_bf16 v83, v123, v123
    v_dot2c_f32_bf16 v80, v124, v88
    v_dot2c_f32_bf16 v82, v124, v124
    v_dot2c_f32_bf16 v81, v125, v88
    v_dot2c_f32_bf16 v83, v125, v125
    v_dot2c_f32_bf16 v80, v126, v88
    v_dot2c_f32_bf16 v82, v126, v126
    v_dot2c_f32_bf16 v81, v127, v88
    v_dot2c_f32_bf16 v83, v127, v127
    s_waitcnt lgkmcnt(0)
    v_dot2c_f32_bf16 v84, v64, v88
    v_dot2c_f32_bf16 v85, v68, v88
    v_dot2c_f32_bf16 v84, v65, v88
    v_dot2c_f32_bf16 v85, v69, v88
    v_dot2c_f32_bf16 v84, v66, v88
    v_dot2c_f32_bf16 v85, v70, v88
    v_dot2c_f32_bf16 v84, v67, v88
    v_dot2c_f32_bf16 v85, v71, v88
    s_waitcnt vmcnt(18)
    ds_read_b128 v[128:131], v242 offset:9216
    ds_read_b128 v[132:135], v243 offset:9216
    ds_read_b128 v[136:139], v244 offset:9216
    ds_read_b128 v[140:143], v245 offset:9216
    ds_read_b64_tr_b16 v[64:65], v246 offset:8192
    ds_read_b64_tr_b16 v[66:67], v247 offset:8192
    ds_read_b64_tr_b16 v[68:69], v246 offset:36864
    ds_read_b64_tr_b16 v[70:71], v247 offset:36864
    s_add_u32 m0, s41, 24576
    s_add_u32 s19, s40, 1033088
    buffer_load_dwordx4 v240, s[44:47], s19 offen lds
    s_add_u32 m0, s41, 53248
    s_add_u32 s19, s40, 1033984
    buffer_load_dwordx4 v240, s[44:47], s19 offen lds
    s_waitcnt lgkmcnt(4)
    s_add_u32 m0, s26, 9216
    s_add_u32 s19, s11, 768
    buffer_load_dwordx4 v241, s[36:39], s19 offen offset:0 lds
    s_add_u32 s19, s11, 6784
    buffer_load_dwordx4 v241, s[36:39], s19 offen offset:1152 lds
    s_add_u32 s19, s11, 12800
    buffer_load_dwordx4 v241, s[36:39], s19 offen offset:2304 lds
    s_add_u32 s19, s11, 18816
    buffer_load_dwordx4 v241, s[36:39], s19 offen offset:3456 lds
    v_dot2c_f32_bf16 v80, v128, v88
    v_dot2c_f32_bf16 v82, v128, v128
    v_dot2c_f32_bf16 v81, v129, v88
    v_dot2c_f32_bf16 v83, v129, v129
    v_dot2c_f32_bf16 v80, v130, v88
    v_dot2c_f32_bf16 v82, v130, v130
    v_dot2c_f32_bf16 v81, v131, v88
    v_dot2c_f32_bf16 v83, v131, v131
    v_dot2c_f32_bf16 v80, v132, v88
    v_dot2c_f32_bf16 v82, v132, v132
    v_dot2c_f32_bf16 v81, v133, v88
    v_dot2c_f32_bf16 v83, v133, v133
    v_dot2c_f32_bf16 v80, v134, v88
    v_dot2c_f32_bf16 v82, v134, v134
    v_dot2c_f32_bf16 v81, v135, v88
    v_dot2c_f32_bf16 v83, v135, v135
    v_dot2c_f32_bf16 v80, v136, v88
    v_dot2c_f32_bf16 v82, v136, v136
    v_dot2c_f32_bf16 v81, v137, v88
    v_dot2c_f32_bf16 v83, v137, v137
    v_dot2c_f32_bf16 v80, v138, v88
    v_dot2c_f32_bf16 v82, v138, v138
    v_dot2c_f32_bf16 v81, v139, v88
    v_dot2c_f32_bf16 v83, v139, v139
    v_dot2c_f32_bf16 v80, v140, v88
    v_dot2c_f32_bf16 v82, v140, v140
    v_dot2c_f32_bf16 v81, v141, v88
    v_dot2c_f32_bf16 v83, v141, v141
    v_dot2c_f32_bf16 v80, v142, v88
    v_dot2c_f32_bf16 v82, v142, v142
    v_dot2c_f32_bf16 v81, v143, v88
    v_dot2c_f32_bf16 v83, v143, v143
    s_waitcnt lgkmcnt(0)
    v_dot2c_f32_bf16 v84, v64, v88
    v_dot2c_f32_bf16 v85, v68, v88
    v_dot2c_f32_bf16 v84, v65, v88
    v_dot2c_f32_bf16 v85, v69, v88
    v_dot2c_f32_bf16 v84, v66, v88
    s_cbranch_execz L_walk
    v_dot2c_f32_bf16 v85, v70, v88
    v_dot2c_f32_bf16 v84, v67, v88
    v_dot2c_f32_bf16 v85, v71, v88
    s_waitcnt vmcnt(18)
    ds_read_b128 v[144:147], v242 offset:13824
    ds_read_b128 v[148:151], v243 offset:13824
    ds_read_b128 v[152:155], v244 offset:13824
    ds_read_b128 v[156:159], v245 offset:13824
    ds_read_b64_tr_b16 v[64:65], v246 offset:12288
    ds_read_b64_tr_b16 v[66:67], v247 offset:12288
    ds_read_b64_tr_b16 v[68:69], v246 offset:40960
    ds_read_b64_tr_b16 v[70:71], v247 offset:40960
    s_waitcnt lgkmcnt(4)
    v_dot2c_f32_bf16 v80, v144, v88
    v_dot2c_f32_bf16 v82, v144, v144
    v_dot2c_f32_bf16 v81, v145, v88
    v_dot2c_f32_bf16 v83, v145, v145
    v_dot2c_f32_bf16 v80, v146, v88
    v_dot2c_f32_bf16 v82, v146, v146
    v_dot2c_f32_bf16 v81, v147, v88
    v_dot2c_f32_bf16 v83, v147, v147
    v_dot2c_f32_bf16 v80, v148, v88
    v_dot2c_f32_bf16 v82, v148, v148
    v_dot2c_f32_bf16 v81, v149, v88
    v_dot2c_f32_bf16 v83, v149, v149
    v_dot2c_f32_bf16 v80, v150, v88
    v_dot2c_f32_bf16 v82, v150, v150
    v_dot2c_f32_bf16 v81, v151, v88
    v_dot2c_f32_bf16 v83, v151, v151
    v_dot2c_f32_bf16 v80, v152, v88
    v_dot2c_f32_bf16 v82, v152, v152
    v_dot2c_f32_bf16 v81, v153, v88
    v_dot2c_f32_bf16 v83, v153, v153
    v_dot2c_f32_bf16 v80, v154, v88
    v_dot2c_f32_bf16 v82, v154, v154
    v_dot2c_f32_bf16 v81, v155, v88
    v_dot2c_f32_bf16 v83, v155, v155
    v_dot2c_f32_bf16 v80, v156, v88
    v_dot2c_f32_bf16 v82, v156, v156
    v_dot2c_f32_bf16 v81, v157, v88
    v_dot2c_f32_bf16 v83, v157, v157
    v_dot2c_f32_bf16 v80, v158, v88
    v_dot2c_f32_bf16 v82, v158, v158
    v_dot2c_f32_bf16 v81, v159, v88
    v_dot2c_f32_bf16 v83, v159, v159
    s_waitcnt lgkmcnt(0)
    v_dot2c_f32_bf16 v84, v64, v88
    v_dot2c_f32_bf16 v85, v68, v88
    v_dot2c_f32_bf16 v84, v65, v88
    v_dot2c_f32_bf16 v85, v69, v88
    v_dot2c_f32_bf16 v84, v66, v88
    v_dot2c_f32_bf16 v85, v70, v88
    v_dot2c_f32_bf16 v84, v67, v88
    v_dot2c_f32_bf16 v85, v71, v88
    s_barrier
    ds_read_b64_tr_b16 a[112:113], v208 offset:0
    ds_read_b64_tr_b16 a[114:115], v209 offset:0
    ds_read_b64_tr_b16 a[116:117], v208 offset:28672
    ds_read_b64_tr_b16 a[118:119], v209 offset:28672
    ds_read_b64_tr_b16 a[120:121], v208 offset:1024
    ds_read_b64_tr_b16 a[122:123], v209 offset:1024
    ds_read_b64_tr_b16 a[124:125], v208 offset:29696
    ds_read_b64_tr_b16 a[126:127], v209 offset:29696
    ds_read_b64_tr_b16 a[128:129], v208 offset:2048
    ds_read_b64_tr_b16 a[130:131], v209 offset:2048
    ds_read_b64_tr_b16 a[132:133], v208 offset:30720
    ds_read_b64_tr_b16 a[134:135], v209 offset:30720
    s_waitcnt lgkmcnt(8)
    v_mfma_f32_32x32x16_bf16 v[32:47], a[112:115], v[96:99], 0
    ds_read_b64_tr_b16 a[136:137], v208 offset:3072
    ds_read_b64_tr_b16 a[138:139], v209 offset:3072
    v_mfma_f32_32x32x16_bf16 v[48:63], v[96:99], a[116:119], 0
    ds_read_b64_tr_b16 a[140:141], v208 offset:31744
    ds_read_b64_tr_b16 a[142:143], v209 offset:31744
    s_waitcnt lgkmcnt(8)
    v_mfma_f32_32x32x16_bf16 v[32:47], a[120:123], v[100:103], v[32:47]
    ds_read_b64_tr_b16 a[112:113], v208 offset:4096
    ds_read_b64_tr_b16 a[114:115], v209 offset:4096
    v_mfma_f32_32x32x16_bf16 v[48:63], v[100:103], a[124:127], v[48:63]
    ds_read_b64_tr_b16 a[116:117], v208 offset:32768
    ds_read_b64_tr_b16 a[118:119], v209 offset:32768
    s_waitcnt lgkmcnt(8)
    v_mfma_f32_32x32x16_bf16 v[32:47], a[128:131], v[104:107], v[32:47]
    ds_read_b64_tr_b16 a[120:121], v208 offset:5120
    ds_read_b64_tr_b16 a[122:123], v209 offset:5120
    v_mfma_f32_32x32x16_bf16 v[48:63], v[104:107], a[132:135], v[48:63]
    ds_read_b64_tr_b16 a[124:125], v208 offset:33792
    ds_read_b64_tr_b16 a[126:127], v209 offset:33792
    s_waitcnt lgkmcnt(8)
    s_cbranch_execz L_walk
    v_mfma_f32_32x32x16_bf16 v[32:47], a[136:139], v[108:111], v[32:47]
    ds_read_b64_tr_b16 a[128:129], v208 offset:6144
    ds_read_b64_tr_b16 a[130:131], v209 offset:6144
    v_mfma_f32_32x32x16_bf16 v[48:63], v[108:111], a[140:143], v[48:63]
    ds_read_b64_tr_b16 a[132:133], v208 offset:34816
    ds_read_b64_tr_b16 a[134:135], v209 offset:34816
    s_waitcnt lgkmcnt(8)
    v_mfma_f32_32x32x16_bf16 v[32:47], a[112:115], v[112:115], v[32:47]
    s_add_u32 m0, s41, 57344
    s_add_u32 s19, s40, 0
    buffer_load_dwordx4 v240, s[44:47], s19 offen lds
    ds_read_b64_tr_b16 a[136:137], v208 offset:7168
    ds_read_b64_tr_b16 a[138:139], v209 offset:7168
    v_mfma_f32_32x32x16_bf16 v[48:63], v[112:115], a[116:119], v[48:63]
    ds_read_b64_tr_b16 a[140:141], v208 offset:35840
    ds_read_b64_tr_b16 a[142:143], v209 offset:35840
    s_waitcnt lgkmcnt(8)
    v_mfma_f32_32x32x16_bf16 v[32:47], a[120:123], v[116:119], v[32:47]
    s_add_u32 m0, s41, 61440
    s_add_u32 s19, s40, 172032
    buffer_load_dwordx4 v240, s[44:47], s19 offen lds
    ds_read_b64_tr_b16 a[112:113], v208 offset:8192
    ds_read_b64_tr_b16 a[114:115], v209 offset:8192
    v_mfma_f32_32x32x16_bf16 v[48:63], v[116:119], a[124:127], v[48:63]
    ds_read_b64_tr_b16 a[116:117], v208 offset:36864
    ds_read_b64_tr_b16 a[118:119], v209 offset:36864
    s_waitcnt lgkmcnt(8)
    v_mfma_f32_32x32x16_bf16 v[32:47], a[128:131], v[120:123], v[32:47]
    s_add_u32 m0, s41, 65536
    s_add_u32 s19, s40, 344064
    buffer_load_dwordx4 v240, s[44:47], s19 offen lds
    ds_read_b64_tr_b16 a[120:121], v208 offset:9216
    ds_read_b64_tr_b16 a[122:123], v209 offset:9216
    v_mfma_f32_32x32x16_bf16 v[48:63], v[120:123], a[132:135], v[48:63]
    ds_read_b64_tr_b16 a[124:125], v208 offset:37888
    ds_read_b64_tr_b16 a[126:127], v209 offset:37888
    s_waitcnt lgkmcnt(8)
    v_mfma_f32_32x32x16_bf16 v[32:47], a[136:139], v[124:127], v[32:47]
    s_add_u32 m0, s41, 69632
    s_add_u32 s19, s40, 516096
    buffer_load_dwordx4 v240, s[44:47], s19 offen lds
    ds_read_b64_tr_b16 a[128:129], v208 offset:10240
    ds_read_b64_tr_b16 a[130:131], v209 offset:10240
    v_mfma_f32_32x32x16_bf16 v[48:63], v[124:127], a[140:143], v[48:63]
    ds_read_b64_tr_b16 a[132:133], v208 offset:38912
    ds_read_b64_tr_b16 a[134:135], v209 offset:38912
    s_waitcnt lgkmcnt(8)
    v_mfma_f32_32x32x16_bf16 v[32:47], a[112:115], v[128:131], v[32:47]
    s_add_u32 m0, s41, 73728
    s_add_u32 s19, s40, 688128
    buffer_load_dwordx4 v240, s[44:47], s19 offen lds
    ds_read_b64_tr_b16 a[136:137], v208 offset:11264
    ds_read_b64_tr_b16 a[138:139], v209 offset:11264
    v_mfma_f32_32x32x16_bf16 v[48:63], v[128:131], a[116:119], v[48:63]
    ds_read_b64_tr_b16 a[140:141], v208 offset:39936
    ds_read_b64_tr_b16 a[142:143], v209 offset:39936
    s_waitcnt lgkmcnt(8)
    v_mfma_f32_32x32x16_bf16 v[32:47], a[120:123], v[132:135], v[32:47]
    s_add_u32 m0, s41, 77824
    s_add_u32 s19, s40, 860160
    buffer_load_dwordx4 v240, s[44:47], s19 offen lds
    ds_read_b64_tr_b16 a[112:113], v208 offset:12288
    ds_read_b64_tr_b16 a[114:115], v209 offset:12288
    v_mfma_f32_32x32x16_bf16 v[48:63], v[132:135], a[124:127], v[48:63]
    ds_read_b64_tr_b16 a[116:117], v208 offset:40960
    ds_read_b64_tr_b16 a[118:119], v209 offset:40960
    s_waitcnt lgkmcnt(8)
    s_nop 0
    s_cbranch_execz L_walk
    v_mfma_f32_32x32x16_bf16 v[32:47], a[128:131], v[136:139], v[32:47]
    s_add_u32 m0, s41, 81920
    s_add_u32 s19, s40, 1032192
    buffer_load_dwordx4 v240, s[44:47], s19 offen lds
    ds_read_b64_tr_b16 a[120:121], v208 offset:13312
    ds_read_b64_tr_b16 a[122:123], v209 offset:13312
    v_mfma_f32_32x32x16_bf16 v[48:63], v[136:139], a[132:135], v[48:63]
    s_mov_b32 s44, s62
    s_mov_b32 s45, s63
    s_mov_b32 s46, 256
    s_mov_b32 s47, 0x20000
    buffer_load_dwordx2 v[214:215], off, s[44:47], 0 sc0 sc1
    ds_read_b64_tr_b16 a[124:125], v208 offset:41984
    ds_read_b64_tr_b16 a[126:127], v209 offset:41984
    s_waitcnt lgkmcnt(8)
    v_mfma_f32_32x32x16_bf16 v[32:47], a[136:139], v[140:143], v[32:47]
    s_cmp_ge_u32 s34, 7
    s_cselect_b32 s12, 64, 0
    s_add_u32 s12, s12, s10
    s_min_u32 s79, s12, 111
    ds_read_b64_tr_b16 a[128:129], v208 offset:14336
    ds_read_b64_tr_b16 a[130:131], v209 offset:14336
    v_mfma_f32_32x32x16_bf16 v[48:63], v[140:143], a[140:143], v[48:63]
    s_and_b32 s35, s12, 31
    s_mul_i32 s13, s79, 14336
    s_lshl_b32 s27, s33, 7
    s_add_u32 s13, s13, s27
    ds_read_b64_tr_b16 a[132:133], v208 offset:43008
    ds_read_b64_tr_b16 a[134:135], v209 offset:43008
    s_waitcnt lgkmcnt(8)
    v_mfma_f32_32x32x16_bf16 v[32:47], a[112:115], v[144:147], v[32:47]
    s_mul_i32 s19, s3, 19456
    s_add_u32 m0, s19, 99840
    s_mov_b32 s36, s58
    s_mov_b32 s37, s59
    ds_read_b64_tr_b16 a[136:137], v208 offset:15360
    ds_read_b64_tr_b16 a[138:139], v209 offset:15360
    v_mfma_f32_32x32x16_bf16 v[48:63], v[144:147], a[116:119], v[48:63]
    s_mov_b32 s38, 1605632
    buffer_load_dwordx4 v216, s[36:39], s13 offen lds
    s_add_u32 s13, s13, 6144
    s_nop 0
    ds_read_b64_tr_b16 a[140:141], v208 offset:44032
    ds_read_b64_tr_b16 a[142:143], v209 offset:44032
    s_waitcnt lgkmcnt(8)
    v_mfma_f32_32x32x16_bf16 v[32:47], a[120:123], v[148:151], v[32:47]
    s_nop 0
    buffer_load_dwordx4 v216, s[36:39], s13 offen offset:1024 lds
    s_lshr_b32 s13, s35, 1
    s_mul_i32 s13, s13, 25088
    v_mfma_f32_32x32x16_bf16 v[48:63], v[148:151], a[124:127], v[48:63]
    s_and_b32 s12, s35, 1
    s_mul_i32 s12, s12, 14336
    s_add_u32 s13, s13, s12
    s_add_u32 s13, s13, s27
    s_waitcnt lgkmcnt(4)
    v_mfma_f32_32x32x16_bf16 v[32:47], a[128:131], v[152:155], v[32:47]
    s_add_u32 m0, s19, 101888
    s_mov_b32 s36, s52
    s_mov_b32 s37, s53
    s_mov_b32 s38, 401408
    v_mfma_f32_32x32x16_bf16 v[48:63], v[152:155], a[132:135], v[48:63]
    buffer_load_dwordx4 v216, s[36:39], s13 offen lds
    s_add_u32 s13, s13, 6144
    s_nop 0
    s_nop 0
    s_waitcnt lgkmcnt(0)
    v_mfma_f32_32x32x16_bf16 v[32:47], a[136:139], v[156:159], v[32:47]
    buffer_load_dwordx4 v216, s[36:39], s13 offen offset:1024 lds
    v_mfma_f32_32x32x16_bf16 v[48:63], v[156:159], a[140:143], v[48:63]
    s_waitcnt vmcnt(24)
    ds_read_b128 v[160:163], v242 offset:0
    ds_read_b128 v[164:167], v243 offset:0
    ds_read_b128 v[168:171], v244 offset:0
    ds_read_b128 v[172:175], v245 offset:0
    ds_read_b64_tr_b16 v[64:65], v246 offset:16384
    s_nop 0
    s_cbranch_execz L_walk
    ds_read_b64_tr_b16 v[66:67], v247 offset:16384
    ds_read_b64_tr_b16 v[68:69], v246 offset:45056
    ds_read_b64_tr_b16 v[70:71], v247 offset:45056
    s_waitcnt lgkmcnt(4)
    v_dot2c_f32_bf16 v80, v160, v88
    v_dot2c_f32_bf16 v82, v160, v160
    v_dot2c_f32_bf16 v81, v161, v88
    v_dot2c_f32_bf16 v83, v161, v161
    v_dot2c_f32_bf16 v80, v162, v88
    v_dot2c_f32_bf16 v82, v162, v162
    v_dot2c_f32_bf16 v81, v163, v88
    v_dot2c_f32_bf16 v83, v163, v163
    v_dot2c_f32_bf16 v80, v164, v88
    v_dot2c_f32_bf16 v82, v164, v164
    v_dot2c_f32_bf16 v81, v165, v88
    v_dot2c_f32_bf16 v83, v165, v165
    v_dot2c_f32_bf16 v80, v166, v88
    v_dot2c_f32_bf16 v82, v166, v166
    v_dot2c_f32_bf16 v81, v167, v88
    v_dot2c_f32_bf16 v83, v167, v167
    v_dot2c_f32_bf16 v80, v168, v88
    v_dot2c_f32_bf16 v82, v168, v168
    v_dot2c_f32_bf16 v81, v169, v88
    v_dot2c_f32_bf16 v83, v169, v169
    v_dot2c_f32_bf16 v80, v170, v88
    v_dot2c_f32_bf16 v82, v170, v170
    v_dot2c_f32_bf16 v81, v171, v88
    v_dot2c_f32_bf16 v83, v171, v171
    v_dot2c_f32_bf16 v80, v172, v88
    v_dot2c_f32_bf16 v82, v172, v172
    v_dot2c_f32_bf16 v81, v173, v88
    v_dot2c_f32_bf16 v83, v173, v173
    v_dot2c_f32_bf16 v80, v174, v88
    v_dot2c_f32_bf16 v82, v174, v174
    v_dot2c_f32_bf16 v81, v175, v88
    v_dot2c_f32_bf16 v83, v175, v175
    s_waitcnt lgkmcnt(0)
    v_dot2c_f32_bf16 v84, v64, v88
    v_dot2c_f32_bf16 v85, v68, v88
    v_dot2c_f32_bf16 v84, v65, v88
    v_dot2c_f32_bf16 v85, v69, v88
    v_dot2c_f32_bf16 v84, v66, v88
    v_dot2c_f32_bf16 v85, v70, v88
    v_dot2c_f32_bf16 v84, v67, v88
    v_dot2c_f32_bf16 v85, v71, v88
    s_waitcnt vmcnt(18)
    ds_read_b128 v[176:179], v242 offset:4608
    ds_read_b128 v[180:183], v243 offset:4608
    ds_read_b128 v[184:187], v244 offset:4608
    ds_read_b128 v[188:191], v245 offset:4608
    ds_read_b64_tr_b16 v[64:65], v246 offset:20480
    ds_read_b64_tr_b16 v[66:67], v247 offset:20480
    ds_read_b64_tr_b16 v[68:69], v246 offset:49152
    ds_read_b64_tr_b16 v[70:71], v247 offset:49152
    s_waitcnt lgkmcnt(4)
    v_dot2c_f32_bf16 v80, v176, v88
    v_dot2c_f32_bf16 v82, v176, v176
    v_dot2c_f32_bf16 v81, v177, v88
    v_dot2c_f32_bf16 v83, v177, v177
    v_dot2c_f32_bf16 v80, v178, v88
    v_dot2c_f32_bf16 v82, v178, v178
    v_dot2c_f32_bf16 v81, v179, v88
    v_dot2c_f32_bf16 v83, v179, v179
    v_dot2c_f32_bf16 v80, v180, v88
    v_dot2c_f32_bf16 v82, v180, v180
    v_dot2c_f32_bf16 v81, v181, v88
    v_dot2c_f32_bf16 v83, v181, v181
    v_dot2c_f32_bf16 v80, v182, v88
    v_dot2c_f32_bf16 v82, v182, v182
    v_dot2c_f32_bf16 v81, v183, v88
    v_dot2c_f32_bf16 v83, v183, v183
    v_dot2c_f32_bf16 v80, v184, v88
    v_dot2c_f32_bf16 v82, v184, v184
    v_dot2c_f32_bf16 v81, v185, v88
    v_dot2c_f32_bf16 v83, v185, v185
    v_dot2c_f32_bf16 v80, v186, v88
    v_dot2c_f32_bf16 v82, v186, v186
    v_dot2c_f32_bf16 v81, v187, v88
    v_dot2c_f32_bf16 v83, v187, v187
    v_dot2c_f32_bf16 v80, v188, v88
    v_dot2c_f32_bf16 v82, v188, v188
    v_dot2c_f32_bf16 v81, v189, v88
    v_dot2c_f32_bf16 v83, v189, v189
    v_dot2c_f32_bf16 v80, v190, v88
    v_dot2c_f32_bf16 v82, v190, v190
    v_dot2c_f32_bf16 v81, v191, v88
    v_dot2c_f32_bf16 v83, v191, v191
    s_waitcnt lgkmcnt(0)
    v_dot2c_f32_bf16 v84, v64, v88
    v_dot2c_f32_bf16 v85, v68, v88
    v_dot2c_f32_bf16 v84, v65, v88
    v_dot2c_f32_bf16 v85, v69, v88
    v_dot2c_f32_bf16 v84, v66, v88
    v_dot2c_f32_bf16 v85, v70, v88
    v_dot2c_f32_bf16 v84, v67, v88
    v_dot2c_f32_bf16 v85, v71, v88
    s_waitcnt vmcnt(12)
    ds_read_b128 v[192:195], v242 offset:9216
    ds_read_b128 v[196:199], v243 offset:9216
    ds_read_b128 v[200:203], v244 offset:9216
    ds_read_b128 v[204:207], v245 offset:9216
    ds_read_b64_tr_b16 v[64:65], v246 offset:24576
    ds_read_b64_tr_b16 v[66:67], v247 offset:24576
    ds_read_b64_tr_b16 v[68:69], v246 offset:53248
    ds_read_b64_tr_b16 v[70:71], v247 offset:53248
    s_waitcnt lgkmcnt(4)
    v_dot2c_f32_bf16 v80, v192, v88
    v_dot2c_f32_bf16 v82, v192, v192
    s_cbranch_execz L_walk
    v_dot2c_f32_bf16 v81, v193, v88
    v_dot2c_f32_bf16 v83, v193, v193
    v_dot2c_f32_bf16 v80, v194, v88
    v_dot2c_f32_bf16 v82, v194, v194
    v_dot2c_f32_bf16 v81, v195, v88
    v_dot2c_f32_bf16 v83, v195, v195
    v_dot2c_f32_bf16 v80, v196, v88
    v_dot2c_f32_bf16 v82, v196, v196
    v_dot2c_f32_bf16 v81, v197, v88
    v_dot2c_f32_bf16 v83, v197, v197
    v_dot2c_f32_bf16 v80, v198, v88
    v_dot2c_f32_bf16 v82, v198, v198
    v_dot2c_f32_bf16 v81, v199, v88
    v_dot2c_f32_bf16 v83, v199, v199
    v_dot2c_f32_bf16 v80, v200, v88
    v_dot2c_f32_bf16 v82, v200, v200
    v_dot2c_f32_bf16 v81, v201, v88
    v_dot2c_f32_bf16 v83, v201, v201
    v_dot2c_f32_bf16 v80, v202, v88
    v_dot2c_f32_bf16 v82, v202, v202
    v_dot2c_f32_bf16 v81, v203, v88
    v_dot2c_f32_bf16 v83, v203, v203
    v_dot2c_f32_bf16 v80, v204, v88
    v_dot2c_f32_bf16 v82, v204, v204
    v_dot2c_f32_bf16 v81, v205, v88
    v_dot2c_f32_bf16 v83, v205, v205
    v_dot2c_f32_bf16 v80, v206, v88
    v_dot2c_f32_bf16 v82, v206, v206
    v_dot2c_f32_bf16 v81, v207, v88
    v_dot2c_f32_bf16 v83, v207, v207
    s_waitcnt lgkmcnt(0)
    v_dot2c_f32_bf16 v84, v64, v88
    v_dot2c_f32_bf16 v85, v68, v88
    v_dot2c_f32_bf16 v84, v65, v88
    v_dot2c_f32_bf16 v85, v69, v88
    v_dot2c_f32_bf16 v84, v66, v88
    v_dot2c_f32_bf16 v85, v70, v88
    v_dot2c_f32_bf16 v84, v67, v88
    v_dot2c_f32_bf16 v85, v71, v88
    v_add_u32 v14, s26, v4
    v_add_u32 v15, 104448, v4
    s_nop 0
    v_permlane32_swap_b32 v84, v85
    v_add_f32 v84, v84, v85
    ds_write_b32 v14, v84 offset:18432
    s_waitcnt lgkmcnt(0)
    s_barrier
    ds_read_b64_tr_b16 a[112:113], v208 offset:16384
    ds_read_b64_tr_b16 a[114:115], v209 offset:16384
    ds_read_b64_tr_b16 a[116:117], v208 offset:45056
    ds_read_b64_tr_b16 a[118:119], v209 offset:45056
    ds_read_b64_tr_b16 a[120:121], v208 offset:17408
    ds_read_b64_tr_b16 a[122:123], v209 offset:17408
    ds_read_b64_tr_b16 a[124:125], v208 offset:46080
    ds_read_b64_tr_b16 a[126:127], v209 offset:46080
    ds_read_b64_tr_b16 a[128:129], v208 offset:18432
    ds_read_b64_tr_b16 a[130:131], v209 offset:18432
    ds_read_b64_tr_b16 a[132:133], v208 offset:47104
    ds_read_b64_tr_b16 a[134:135], v209 offset:47104
    s_waitcnt lgkmcnt(8)
    v_mfma_f32_32x32x16_bf16 v[32:47], a[112:115], v[160:163], v[32:47]
    ds_read_b32 v64, v15 offset:0
    ds_read_b32 v65, v15 offset:19456
    ds_read_b32 v66, v15 offset:38912
    ds_read_b32 v67, v15 offset:58368
    ds_read_b64_tr_b16 a[136:137], v208 offset:19456
    ds_read_b64_tr_b16 a[138:139], v209 offset:19456
    v_mfma_f32_32x32x16_bf16 v[48:63], v[160:163], a[116:119], v[48:63]
    v_add_f32 v80, v80, v81
    v_add_f32 v82, v82, v83
    s_nop 1
    ds_read_b64_tr_b16 a[140:141], v208 offset:48128
    s_waitcnt lgkmcnt(14)
    ds_read_b64_tr_b16 a[142:143], v209 offset:48128
    s_waitcnt lgkmcnt(12)
    v_mfma_f32_32x32x16_bf16 v[32:47], a[120:123], v[164:167], v[32:47]
    v_permlane32_swap_b32 v80, v82
    v_add_f32 v80, v80, v82
    v_mul_f32 v80, 0x3b124925, v80
    ds_read_b64_tr_b16 a[112:113], v208 offset:20480
    ds_read_b64_tr_b16 a[114:115], v209 offset:20480
    v_mfma_f32_32x32x16_bf16 v[48:63], v[164:167], a[124:127], v[48:63]
    v_mov_b32 v81, v80
    s_nop 1
    v_permlane32_swap_b32 v80, v81
    ds_read_b64_tr_b16 a[116:117], v208 offset:49152
    s_waitcnt lgkmcnt(14)
    ds_read_b64_tr_b16 a[118:119], v209 offset:49152
    s_waitcnt lgkmcnt(12)
    v_mfma_f32_32x32x16_bf16 v[32:47], a[128:131], v[168:171], v[32:47]
    v_fma_f32 v82, -v80, v80, v81
    v_max_f32 v82, 0, v82
    v_add_f32 v82, 0x3727c5ac, v82
    s_cbranch_execz L_walk
    ds_read_b64_tr_b16 a[120:121], v208 offset:21504
    ds_read_b64_tr_b16 a[122:123], v209 offset:21504
    v_mfma_f32_32x32x16_bf16 v[48:63], v[168:171], a[132:135], v[48:63]
    v_rsq_f32 v12, v82
    v_sub_f32 v80, 0, v80
    v_cvt_pk_bf16_f32 v83, v80, v80
    ds_read_b64_tr_b16 a[124:125], v208 offset:50176
    s_waitcnt lgkmcnt(14)
    ds_read_b64_tr_b16 a[126:127], v209 offset:50176
    s_waitcnt lgkmcnt(8)
    v_mfma_f32_32x32x16_bf16 v[32:47], a[136:139], v[172:175], v[32:47]
    v_and_b32 v84, 0xffff0000, v83
    v_sub_f32 v84, v80, v84
    v_cvt_pk_bf16_f32 v84, v84, v84
    ds_read_b64_tr_b16 a[128:129], v208 offset:22528
    ds_read_b64_tr_b16 a[130:131], v209 offset:22528
    v_mfma_f32_32x32x16_bf16 v[48:63], v[172:175], a[140:143], v[48:63]
    v_cndmask_b32 v238, 0, v83, s[20:21]
    v_cndmask_b32 v239, 0, v84, s[20:21]
    s_mul_i32 s16, s3, 19456
    s_add_u32 s16, s16, 103936
    v_add_u32 v14, s16, v4
    ds_write_b32 v14, v12
    v_lshl_add_u32 v14, v5, 4, s16
    ds_read_b64_tr_b16 a[132:133], v208 offset:51200
    ds_read_b64_tr_b16 a[134:135], v209 offset:51200
    s_waitcnt lgkmcnt(9)
    v_mfma_f32_32x32x16_bf16 v[32:47], a[112:115], v[176:179], v[32:47]
    ds_read_b64_tr_b16 a[136:137], v208 offset:23552
    ds_read_b64_tr_b16 a[138:139], v209 offset:23552
    v_mfma_f32_32x32x16_bf16 v[48:63], v[176:179], a[116:119], v[48:63]
    ds_read_b64_tr_b16 a[140:141], v208 offset:52224
    ds_read_b64_tr_b16 a[142:143], v209 offset:52224
    s_waitcnt lgkmcnt(9)
    v_mfma_f32_32x32x16_bf16 v[32:47], a[120:123], v[180:183], v[32:47]
    s_waitcnt lgkmcnt(6)
    ds_read_b128 v[80:83], v14 offset:0
    ds_read_b128 v[84:87], v14 offset:32
    ds_read_b128 v[88:91], v14 offset:64
    ds_read_b128 v[92:95], v14 offset:96
    ds_read_b64_tr_b16 a[112:113], v208 offset:24576
    ds_read_b64_tr_b16 a[114:115], v209 offset:24576
    v_mfma_f32_32x32x16_bf16 v[48:63], v[180:183], a[124:127], v[48:63]
    ds_read_b64_tr_b16 a[116:117], v208 offset:53248
    ds_read_b64_tr_b16 a[118:119], v209 offset:53248
    s_waitcnt lgkmcnt(12)
    v_mfma_f32_32x32x16_bf16 v[32:47], a[128:131], v[184:187], v[32:47]
    v_add_f32 v64, v64, v65
    v_add_f32 v66, v66, v67
    ds_read_b64_tr_b16 a[120:121], v208 offset:25600
    ds_read_b64_tr_b16 a[122:123], v209 offset:25600
    v_mfma_f32_32x32x16_bf16 v[48:63], v[184:187], a[132:135], v[48:63]
    v_add_f32 v64, v64, v66
    v_mov_b32 v65, v64
    s_nop 1
    ds_read_b64_tr_b16 a[124:125], v208 offset:54272
    s_waitcnt lgkmcnt(14)
    ds_read_b64_tr_b16 a[126:127], v209 offset:54272
    s_waitcnt lgkmcnt(12)
    v_mfma_f32_32x32x16_bf16 v[32:47], a[136:139], v[188:191], v[32:47]
    v_permlane32_swap_b32 v64, v65
    v_cvt_pk_bf16_f32 v68, v64, v64
    v_and_b32 v68, 0xffff0000, v68
    ds_read_b64_tr_b16 a[128:129], v208 offset:26624
    ds_read_b64_tr_b16 a[130:131], v209 offset:26624
    v_mfma_f32_32x32x16_bf16 v[48:63], v[188:191], a[140:143], v[48:63]
    v_sub_f32 v68, v64, v68
    v_cvt_pk_bf16_f32 v226, v64, v68
    v_mov_b32 v227, v226
    ds_read_b64_tr_b16 a[132:133], v208 offset:55296
    s_waitcnt lgkmcnt(14)
    ds_read_b64_tr_b16 a[134:135], v209 offset:55296
    s_waitcnt lgkmcnt(8)
    v_mfma_f32_32x32x16_bf16 v[32:47], a[112:115], v[192:195], v[32:47]
    s_nop 0
    s_cbranch_execz L_walk
    v_cvt_pk_bf16_f32 v69, v65, v65
    v_and_b32 v69, 0xffff0000, v69
    v_sub_f32 v69, v65, v69
    ds_read_b64_tr_b16 a[136:137], v208 offset:27648
    ds_read_b64_tr_b16 a[138:139], v209 offset:27648
    v_mfma_f32_32x32x16_bf16 v[48:63], v[192:195], a[116:119], v[48:63]
    v_cvt_pk_bf16_f32 v228, v65, v69
    v_mov_b32 v229, v228
    ds_read_b64_tr_b16 a[140:141], v208 offset:56320
    ds_read_b64_tr_b16 a[142:143], v209 offset:56320
    s_waitcnt lgkmcnt(8)
    v_mfma_f32_32x32x16_bf16 v[32:47], a[120:123], v[196:199], v[32:47]
    v_mfma_f32_32x32x16_bf16 v[48:63], v[196:199], a[124:127], v[48:63]
    s_waitcnt lgkmcnt(4)
    v_mfma_f32_32x32x16_bf16 v[32:47], a[128:131], v[200:203], v[32:47]
    v_mfma_f32_32x32x16_bf16 v[48:63], v[200:203], a[132:135], v[48:63]
    s_waitcnt lgkmcnt(0)
    v_mfma_f32_32x32x16_bf16 v[32:47], a[136:139], v[204:207], v[32:47]
    v_mfma_f32_32x32x16_bf16 v[48:63], v[204:207], a[140:143], v[48:63]
    s_branch L_qkv2
L_q0b:
    v_mov_b32 v94, 0
    v_mov_b32 v95, 0
    v_mov_b32 v15, 0x3f803f80
    s_waitcnt vmcnt(8)
    ds_read_b64_tr_b16 v[24:25], v248 offset:0
    ds_read_b64_tr_b16 v[26:27], v249 offset:0
    ds_read_b64_tr_b16 v[28:29], v248 offset:4096
    ds_read_b64_tr_b16 v[30:31], v249 offset:4096
    ds_read_b64_tr_b16 v[48:49], v248 offset:8192
    ds_read_b64_tr_b16 v[50:51], v249 offset:8192
    ds_read_b64_tr_b16 v[52:53], v248 offset:12288
    ds_read_b64_tr_b16 v[54:55], v249 offset:12288
    ds_read_b64_tr_b16 v[56:57], v248 offset:16384
    ds_read_b64_tr_b16 v[58:59], v249 offset:16384
    ds_read_b64_tr_b16 v[60:61], v248 offset:20480
    ds_read_b64_tr_b16 v[62:63], v249 offset:20480
    ds_read_b64_tr_b16 v[80:81], v248 offset:24576
    ds_read_b64_tr_b16 v[82:83], v249 offset:24576
    v_readfirstlane_b32 s43, v215
    v_readfirstlane_b32 s42, v214
    s_lshl_b32 s12, s0, 10
    s_add_u32 s13, s0, 64
    s_min_u32 s13, s13, 83
    s_lshl_b32 s13, s13, 10
    s_waitcnt lgkmcnt(0)
    v_dot2c_f32_bf16 v94, v24, v15
    v_dot2c_f32_bf16 v95, v25, v15
    v_dot2c_f32_bf16 v94, v26, v15
    v_dot2c_f32_bf16 v95, v27, v15
    v_dot2c_f32_bf16 v94, v28, v15
    v_dot2c_f32_bf16 v95, v29, v15
    v_dot2c_f32_bf16 v94, v30, v15
    v_dot2c_f32_bf16 v95, v31, v15
    v_dot2c_f32_bf16 v94, v48, v15
    v_dot2c_f32_bf16 v95, v49, v15
    v_dot2c_f32_bf16 v94, v50, v15
    v_dot2c_f32_bf16 v95, v51, v15
    v_dot2c_f32_bf16 v94, v52, v15
    v_dot2c_f32_bf16 v95, v53, v15
    v_dot2c_f32_bf16 v94, v54, v15
    v_dot2c_f32_bf16 v95, v55, v15
    v_dot2c_f32_bf16 v94, v56, v15
    v_dot2c_f32_bf16 v95, v57, v15
    v_dot2c_f32_bf16 v94, v58, v15
    v_dot2c_f32_bf16 v95, v59, v15
    v_dot2c_f32_bf16 v94, v60, v15
    v_dot2c_f32_bf16 v95, v61, v15
    v_dot2c_f32_bf16 v94, v62, v15
    v_dot2c_f32_bf16 v95, v63, v15
    v_dot2c_f32_bf16 v94, v80, v15
    v_dot2c_f32_bf16 v95, v81, v15
    v_dot2c_f32_bf16 v94, v82, v15
    v_dot2c_f32_bf16 v95, v83, v15
    v_add_u32 v14, s26, v4
    v_add_u32 v15, 104704, v4
    v_add_u32 v84, s12, v2
    v_add_u32 v85, s13, v2
    v_add_f32 v94, v94, v95
    ds_write_b32 v14, v94 offset:18688
    s_waitcnt lgkmcnt(0)
    s_barrier
    ds_read_b32 v80, v15 offset:0
    ds_read_b32 v81, v15 offset:19456
    ds_read_b32 v82, v15 offset:38912
    ds_read_b32 v83, v15 offset:58368
    ds_read_b128 a[96:99], v84
    ds_read_b128 a[100:103], v85
    s_cmp_eq_u32 s43, 0
    s_cbranch_scc1 L_tg
    s_cbranch_execz L_walk
L_tb:
    s_waitcnt lgkmcnt(2)
    v_add_f32 v80, v80, v81
    v_add_f32 v82, v82, v83
    v_add_f32 v80, v80, v82
    v_mov_b32 v81, v80
    s_nop 1
    v_permlane32_swap_b32 v80, v81
    v_add_f32 v80, v80, v81
    v_cvt_pk_bf16_f32 v82, v80, v80
    v_and_b32 v82, 0xffff0000, v82
    v_sub_f32 v82, v80, v82
    v_cvt_pk_bf16_f32 v224, v80, v82
    v_mov_b32 v225, v224
    s_waitcnt vmcnt(0) lgkmcnt(0)
    s_mov_b64 exec, 1
    buffer_store_dwordx2 v[214:215], off, s[4:7], s24  sc1
    s_mov_b64 exec, -1
    s_mov_b32 s36, s56
    s_mov_b32 s37, s57
    s_mov_b32 s38, 1605632
    s_mov_b32 s39, 0x20000
    s_lshl_b32 s12, s2, 2
    s_add_u32 s12, s12, s3
    s_mul_i32 s12, s12, 1664
    v_min_u32 v15, 12, v1
    v_lshlrev_b32 v15, 7, v15
    buffer_load_dword v250, v15, s[36:39], s12 offen
    s_branch L_q0r
L_prep:
    s_sub_u32 s12, s79, 56
    s_lshr_b32 s19, s12, 2
    s_lshl_b32 s19, s19, 1
    s_and_b32 s24, s12, 1
    s_add_u32 s19, s19, s24
    s_bitcmp1_b32 s12, 1
    s_cselect_b32 s24, 84, 56
    s_add_u32 s19, s19, s24
    s_cmp_ge_u32 s79, 56
    s_cselect_b32 s19, s19, s79
    s_lshl_b32 s19, s19, 11
    s_mul_i32 s12, s33, 229376
    s_add_u32 s12, s12, s19
    s_add_u32 s12, s12, 0
    s_lshl_b32 s19, s33, 16
    s_lshl_b32 s24, s35, 11
    s_add_u32 s19, s19, s24
    s_add_u32 s19, s19, 1638400
    s_cmp_ge_u32 s34, 7
    s_cselect_b32 s24, 64, 0
    s_add_u32 s24, s24, s10
    s_cmp_ge_u32 s9, 14
    s_cselect_b32 s24, 255, s24
    s_cmp_lt_u32 s24, 112
    s_cselect_b32 s12, s12, 0x7fff0000
    s_lshr_b32 s24, s24, 5
    s_cmp_eq_u32 s24, 3
    s_cselect_b32 s19, s19, 0x7fff0000
    s_bitcmp1_b32 s35, 0
    s_cselect_b32 s25, 0, -1
    s_mov_b32 s24, -1
    s_waitcnt lgkmcnt(0)
    v_cndmask_b32 v98, 0, v98, s[24:25]
    v_cndmask_b32 v99, 0, v99, s[24:25]
    v_cndmask_b32 v102, 0, v102, s[24:25]
    v_cndmask_b32 v103, 0, v103, s[24:25]
    s_lshl_b32 s28, s0, 10
    s_add_u32 s28, s28, s77
    s_add_u32 s29, s28, 0x10000
    s_cmp_lt_u32 s0, 20
    s_cselect_b32 s29, s29, 0x7fff0000
    s_branch L_prepr
L_qkv1:
    s_mul_i32 s11, s0, 28672
    s_add_u32 s11, s11, 3145728
    s_lshl_b32 s14, s0, 12
    s_add_u32 s14, s14, 6815744
    buffer_load_dwordx4 v[96:99], v2, s[4:7], s11 offen offset:0 sc1
    buffer_load_dwordx4 v[100:103], v2, s[4:7], s11 offen offset:1024 sc1
    buffer_load_dwordx4 v[104:107], v2, s[4:7], s11 offen offset:2048 sc1
    buffer_load_dwordx4 v[108:111], v2, s[4:7], s11 offen offset:3072 sc1
    s_add_u32 s11, s11, 4096
    buffer_load_dwordx4 v[112:115], v2, s[4:7], s11 offen offset:0 sc1
    buffer_load_dwordx4 v[116:119], v2, s[4:7], s11 offen offset:1024 sc1
    buffer_load_dwordx4 v[120:123], v2, s[4:7], s11 offen offset:2048 sc1
    buffer_load_dwordx4 v[124:127], v2, s[4:7], s11 offen offset:3072 sc1
    v_mov_b32 v208, v213
    v_add_u32 v209, 512, v213
    s_waitcnt vmcnt(7)
    s_barrier
    ds_read_b64_tr_b16 a[112:113], v208 offset:0
    ds_read_b64_tr_b16 a[114:115], v209 offset:0
    ds_read_b64_tr_b16 a[116:117], v208 offset:28672
    s_cbranch_execz L_walk
    ds_read_b64_tr_b16 a[118:119], v209 offset:28672
    ds_read_b64_tr_b16 a[120:121], v208 offset:1024
    ds_read_b64_tr_b16 a[122:123], v209 offset:1024
    ds_read_b64_tr_b16 a[124:125], v208 offset:29696
    ds_read_b64_tr_b16 a[126:127], v209 offset:29696
    ds_read_b64_tr_b16 a[128:129], v208 offset:2048
    ds_read_b64_tr_b16 a[130:131], v209 offset:2048
    ds_read_b64_tr_b16 a[132:133], v208 offset:30720
    ds_read_b64_tr_b16 a[134:135], v209 offset:30720
    s_waitcnt lgkmcnt(8)
    v_mfma_f32_32x32x16_bf16 v[32:47], a[112:115], v[96:99], 0
    s_add_u32 s11, s11, 4096
    buffer_load_dwordx4 v[128:131], v2, s[4:7], s11 offen offset:0 sc1
    ds_read_b64_tr_b16 a[136:137], v208 offset:3072
    ds_read_b64_tr_b16 a[138:139], v209 offset:3072
    v_mfma_f32_32x32x16_bf16 v[48:63], v[96:99], a[116:119], 0
    buffer_load_dword v80, v4, s[4:7], s14 offen offset:0 sc1
    ds_read_b64_tr_b16 a[140:141], v208 offset:31744
    ds_read_b64_tr_b16 a[142:143], v209 offset:31744
    s_waitcnt vmcnt(8) lgkmcnt(8)
    v_mfma_f32_32x32x16_bf16 v[32:47], a[120:123], v[100:103], v[32:47]
    buffer_load_dwordx4 v[132:135], v2, s[4:7], s11 offen offset:1024 sc1
    ds_read_b64_tr_b16 a[112:113], v208 offset:4096
    ds_read_b64_tr_b16 a[114:115], v209 offset:4096
    v_mfma_f32_32x32x16_bf16 v[48:63], v[100:103], a[124:127], v[48:63]
    buffer_load_dword v81, v4, s[4:7], s14 offen offset:256 sc1
    ds_read_b64_tr_b16 a[116:117], v208 offset:32768
    ds_read_b64_tr_b16 a[118:119], v209 offset:32768
    s_waitcnt vmcnt(9) lgkmcnt(8)
    v_mfma_f32_32x32x16_bf16 v[32:47], a[128:131], v[104:107], v[32:47]
    buffer_load_dwordx4 v[136:139], v2, s[4:7], s11 offen offset:2048 sc1
    ds_read_b64_tr_b16 a[120:121], v208 offset:5120
    ds_read_b64_tr_b16 a[122:123], v209 offset:5120
    v_mfma_f32_32x32x16_bf16 v[48:63], v[104:107], a[132:135], v[48:63]
    buffer_load_dword v82, v4, s[4:7], s14 offen offset:512 sc1
    ds_read_b64_tr_b16 a[124:125], v208 offset:33792
    ds_read_b64_tr_b16 a[126:127], v209 offset:33792
    s_waitcnt vmcnt(10) lgkmcnt(8)
    v_mfma_f32_32x32x16_bf16 v[32:47], a[136:139], v[108:111], v[32:47]
    buffer_load_dwordx4 v[140:143], v2, s[4:7], s11 offen offset:3072 sc1
    ds_read_b64_tr_b16 a[128:129], v208 offset:6144
    ds_read_b64_tr_b16 a[130:131], v209 offset:6144
    v_mfma_f32_32x32x16_bf16 v[48:63], v[108:111], a[140:143], v[48:63]
    buffer_load_dword v83, v4, s[4:7], s14 offen offset:768 sc1
    ds_read_b64_tr_b16 a[132:133], v208 offset:34816
    ds_read_b64_tr_b16 a[134:135], v209 offset:34816
    s_waitcnt vmcnt(11) lgkmcnt(8)
    v_mfma_f32_32x32x16_bf16 v[32:47], a[112:115], v[112:115], v[32:47]
    s_add_u32 s11, s11, 4096
    buffer_load_dwordx4 v[144:147], v2, s[4:7], s11 offen offset:0 sc1
    ds_read_b64_tr_b16 a[136:137], v208 offset:7168
    ds_read_b64_tr_b16 a[138:139], v209 offset:7168
    v_mfma_f32_32x32x16_bf16 v[48:63], v[112:115], a[116:119], v[48:63]
    buffer_load_dword v84, v4, s[4:7], s14 offen offset:1024 sc1
    ds_read_b64_tr_b16 a[140:141], v208 offset:35840
    ds_read_b64_tr_b16 a[142:143], v209 offset:35840
    s_waitcnt vmcnt(12) lgkmcnt(8)
    v_mfma_f32_32x32x16_bf16 v[32:47], a[120:123], v[116:119], v[32:47]
    buffer_load_dwordx4 v[148:151], v2, s[4:7], s11 offen offset:1024 sc1
    ds_read_b64_tr_b16 a[112:113], v208 offset:8192
    ds_read_b64_tr_b16 a[114:115], v209 offset:8192
    v_mfma_f32_32x32x16_bf16 v[48:63], v[116:119], a[124:127], v[48:63]
    buffer_load_dword v85, v4, s[4:7], s14 offen offset:1280 sc1
    ds_read_b64_tr_b16 a[116:117], v208 offset:36864
    ds_read_b64_tr_b16 a[118:119], v209 offset:36864
    s_waitcnt vmcnt(13) lgkmcnt(8)
    v_mfma_f32_32x32x16_bf16 v[32:47], a[128:131], v[120:123], v[32:47]
    s_cbranch_execz L_walk
    buffer_load_dwordx4 v[152:155], v2, s[4:7], s11 offen offset:2048 sc1
    ds_read_b64_tr_b16 a[120:121], v208 offset:9216
    ds_read_b64_tr_b16 a[122:123], v209 offset:9216
    v_mfma_f32_32x32x16_bf16 v[48:63], v[120:123], a[132:135], v[48:63]
    buffer_load_dword v86, v4, s[4:7], s14 offen offset:1536 sc1
    ds_read_b64_tr_b16 a[124:125], v208 offset:37888
    ds_read_b64_tr_b16 a[126:127], v209 offset:37888
    s_waitcnt vmcnt(14) lgkmcnt(8)
    v_mfma_f32_32x32x16_bf16 v[32:47], a[136:139], v[124:127], v[32:47]
    buffer_load_dwordx4 v[156:159], v2, s[4:7], s11 offen offset:3072 sc1
    ds_read_b64_tr_b16 a[128:129], v208 offset:10240
    ds_read_b64_tr_b16 a[130:131], v209 offset:10240
    v_mfma_f32_32x32x16_bf16 v[48:63], v[124:127], a[140:143], v[48:63]
    buffer_load_dword v87, v4, s[4:7], s14 offen offset:1792 sc1
    ds_read_b64_tr_b16 a[132:133], v208 offset:38912
    ds_read_b64_tr_b16 a[134:135], v209 offset:38912
    s_waitcnt vmcnt(15) lgkmcnt(8)
    v_mfma_f32_32x32x16_bf16 v[32:47], a[112:115], v[128:131], v[32:47]
    s_add_u32 s11, s11, 4096
    buffer_load_dwordx4 v[160:163], v2, s[4:7], s11 offen offset:0 sc1
    ds_read_b64_tr_b16 a[136:137], v208 offset:11264
    ds_read_b64_tr_b16 a[138:139], v209 offset:11264
    v_mfma_f32_32x32x16_bf16 v[48:63], v[128:131], a[116:119], v[48:63]
    buffer_load_dword v88, v4, s[4:7], s14 offen offset:2048 sc1
    ds_read_b64_tr_b16 a[140:141], v208 offset:39936
    ds_read_b64_tr_b16 a[142:143], v209 offset:39936
    s_waitcnt vmcnt(15) lgkmcnt(8)
    v_mfma_f32_32x32x16_bf16 v[32:47], a[120:123], v[132:135], v[32:47]
    buffer_load_dwordx4 v[164:167], v2, s[4:7], s11 offen offset:1024 sc1
    ds_read_b64_tr_b16 a[112:113], v208 offset:12288
    ds_read_b64_tr_b16 a[114:115], v209 offset:12288
    v_mfma_f32_32x32x16_bf16 v[48:63], v[132:135], a[124:127], v[48:63]
    buffer_load_dword v89, v4, s[4:7], s14 offen offset:2304 sc1
    ds_read_b64_tr_b16 a[116:117], v208 offset:40960
    ds_read_b64_tr_b16 a[118:119], v209 offset:40960
    s_waitcnt vmcnt(15) lgkmcnt(8)
    v_mfma_f32_32x32x16_bf16 v[32:47], a[128:131], v[136:139], v[32:47]
    buffer_load_dwordx4 v[168:171], v2, s[4:7], s11 offen offset:2048 sc1
    ds_read_b64_tr_b16 a[120:121], v208 offset:13312
    ds_read_b64_tr_b16 a[122:123], v209 offset:13312
    v_mfma_f32_32x32x16_bf16 v[48:63], v[136:139], a[132:135], v[48:63]
    buffer_load_dword v90, v4, s[4:7], s14 offen offset:2560 sc1
    ds_read_b64_tr_b16 a[124:125], v208 offset:41984
    ds_read_b64_tr_b16 a[126:127], v209 offset:41984
    s_waitcnt vmcnt(15) lgkmcnt(8)
    v_mfma_f32_32x32x16_bf16 v[32:47], a[136:139], v[140:143], v[32:47]
    buffer_load_dwordx4 v[172:175], v2, s[4:7], s11 offen offset:3072 sc1
    ds_read_b64_tr_b16 a[128:129], v208 offset:14336
    ds_read_b64_tr_b16 a[130:131], v209 offset:14336
    v_mfma_f32_32x32x16_bf16 v[48:63], v[140:143], a[140:143], v[48:63]
    buffer_load_dword v91, v4, s[4:7], s14 offen offset:2816 sc1
    ds_read_b64_tr_b16 a[132:133], v208 offset:43008
    ds_read_b64_tr_b16 a[134:135], v209 offset:43008
    s_waitcnt vmcnt(15) lgkmcnt(8)
    v_mfma_f32_32x32x16_bf16 v[32:47], a[112:115], v[144:147], v[32:47]
    s_add_u32 s11, s11, 4096
    buffer_load_dwordx4 v[176:179], v2, s[4:7], s11 offen offset:0 sc1
    ds_read_b64_tr_b16 a[136:137], v208 offset:15360
    ds_read_b64_tr_b16 a[138:139], v209 offset:15360
    v_mfma_f32_32x32x16_bf16 v[48:63], v[144:147], a[116:119], v[48:63]
    buffer_load_dword v92, v4, s[4:7], s14 offen offset:3072 sc1
    ds_read_b64_tr_b16 a[140:141], v208 offset:44032
    ds_read_b64_tr_b16 a[142:143], v209 offset:44032
    s_waitcnt vmcnt(15) lgkmcnt(8)
    v_mfma_f32_32x32x16_bf16 v[32:47], a[120:123], v[148:151], v[32:47]
    buffer_load_dwordx4 v[180:183], v2, s[4:7], s11 offen offset:1024 sc1
    ds_read_b64_tr_b16 a[112:113], v208 offset:16384
    s_cbranch_execz L_walk
    ds_read_b64_tr_b16 a[114:115], v209 offset:16384
    v_mfma_f32_32x32x16_bf16 v[48:63], v[148:151], a[124:127], v[48:63]
    buffer_load_dword v93, v4, s[4:7], s14 offen offset:3328 sc1
    ds_read_b64_tr_b16 a[116:117], v208 offset:45056
    ds_read_b64_tr_b16 a[118:119], v209 offset:45056
    s_waitcnt vmcnt(15) lgkmcnt(8)
    v_mfma_f32_32x32x16_bf16 v[32:47], a[128:131], v[152:155], v[32:47]
    buffer_load_dwordx4 v[184:187], v2, s[4:7], s11 offen offset:2048 sc1
    ds_read_b64_tr_b16 a[120:121], v208 offset:17408
    ds_read_b64_tr_b16 a[122:123], v209 offset:17408
    v_mfma_f32_32x32x16_bf16 v[48:63], v[152:155], a[132:135], v[48:63]
    s_mov_b32 m0, s41
    s_add_u32 s41, s41, 4096
    buffer_load_dwordx4 v2, s[4:7], s40 offen sc1 lds
    s_add_u32 s40, s40, 4096
    ds_read_b64_tr_b16 a[124:125], v208 offset:46080
    ds_read_b64_tr_b16 a[126:127], v209 offset:46080
    s_waitcnt vmcnt(15) lgkmcnt(8)
    v_mfma_f32_32x32x16_bf16 v[32:47], a[136:139], v[156:159], v[32:47]
    buffer_load_dwordx4 v[188:191], v2, s[4:7], s11 offen offset:3072 sc1
    ds_read_b64_tr_b16 a[128:129], v208 offset:18432
    ds_read_b64_tr_b16 a[130:131], v209 offset:18432
    v_mfma_f32_32x32x16_bf16 v[48:63], v[156:159], a[140:143], v[48:63]
    s_mov_b32 m0, s41
    s_add_u32 s41, s41, 4096
    buffer_load_dwordx4 v2, s[4:7], s40 offen sc1 lds
    s_add_u32 s40, s40, 4096
    ds_read_b64_tr_b16 a[132:133], v208 offset:47104
    ds_read_b64_tr_b16 a[134:135], v209 offset:47104
    s_waitcnt vmcnt(15) lgkmcnt(8)
    v_mfma_f32_32x32x16_bf16 v[32:47], a[112:115], v[160:163], v[32:47]
    s_add_u32 s11, s11, 4096
    buffer_load_dwordx4 v[192:195], v2, s[4:7], s11 offen offset:0 sc1
    ds_read_b64_tr_b16 a[136:137], v208 offset:19456
    ds_read_b64_tr_b16 a[138:139], v209 offset:19456
    v_mfma_f32_32x32x16_bf16 v[48:63], v[160:163], a[116:119], v[48:63]
    s_mov_b32 m0, s41
    s_add_u32 s41, s41, 4096
    buffer_load_dwordx4 v2, s[4:7], s40 offen sc1 lds
    s_add_u32 s40, s40, 4096
    ds_read_b64_tr_b16 a[140:141], v208 offset:48128
    ds_read_b64_tr_b16 a[142:143], v209 offset:48128
    s_waitcnt vmcnt(15) lgkmcnt(8)
    v_mfma_f32_32x32x16_bf16 v[32:47], a[120:123], v[164:167], v[32:47]
    buffer_load_dwordx4 v[196:199], v2, s[4:7], s11 offen offset:1024 sc1
    ds_read_b64_tr_b16 a[112:113], v208 offset:20480
    ds_read_b64_tr_b16 a[114:115], v209 offset:20480
    v_mfma_f32_32x32x16_bf16 v[48:63], v[164:167], a[124:127], v[48:63]
    s_mov_b32 m0, s41
    s_add_u32 s41, s41, 4096
    buffer_load_dwordx4 v2, s[4:7], s40 offen sc1 lds
    s_add_u32 s40, s40, 4096
    ds_read_b64_tr_b16 a[116:117], v208 offset:49152
    ds_read_b64_tr_b16 a[118:119], v209 offset:49152
    s_waitcnt vmcnt(15) lgkmcnt(8)
    v_mfma_f32_32x32x16_bf16 v[32:47], a[128:131], v[168:171], v[32:47]
    buffer_load_dwordx4 v[200:203], v2, s[4:7], s11 offen offset:2048 sc1
    ds_read_b64_tr_b16 a[120:121], v208 offset:21504
    ds_read_b64_tr_b16 a[122:123], v209 offset:21504
    v_mfma_f32_32x32x16_bf16 v[48:63], v[168:171], a[132:135], v[48:63]
    s_mov_b32 m0, s41
    s_add_u32 s41, s41, 4096
    buffer_load_dwordx4 v2, s[4:7], s40 offen sc1 lds
    s_add_u32 s40, s40, 4096
    ds_read_b64_tr_b16 a[124:125], v208 offset:50176
    ds_read_b64_tr_b16 a[126:127], v209 offset:50176
    s_waitcnt vmcnt(15) lgkmcnt(8)
    v_mfma_f32_32x32x16_bf16 v[32:47], a[136:139], v[172:175], v[32:47]
    buffer_load_dwordx4 v[204:207], v2, s[4:7], s11 offen offset:3072 sc1
    s_cbranch_execz L_walk
    ds_read_b64_tr_b16 a[128:129], v208 offset:22528
    ds_read_b64_tr_b16 a[130:131], v209 offset:22528
    v_mfma_f32_32x32x16_bf16 v[48:63], v[172:175], a[140:143], v[48:63]
    s_mov_b32 m0, s41
    s_add_u32 s41, s41, 4096
    buffer_load_dwordx4 v2, s[4:7], s40 offen sc1 lds
    s_add_u32 s40, s40, 4096
    ds_read_b64_tr_b16 a[132:133], v208 offset:51200
    ds_read_b64_tr_b16 a[134:135], v209 offset:51200
    s_waitcnt vmcnt(15) lgkmcnt(8)
    v_mfma_f32_32x32x16_bf16 v[32:47], a[112:115], v[176:179], v[32:47]
    s_waitcnt vmcnt(12)
    v_add_f32 v80, v80, v81
    v_add_f32 v82, v82, v83
    v_add_f32 v84, v84, v85
    ds_read_b64_tr_b16 a[136:137], v208 offset:23552
    ds_read_b64_tr_b16 a[138:139], v209 offset:23552
    v_mfma_f32_32x32x16_bf16 v[48:63], v[176:179], a[116:119], v[48:63]
    v_add_f32 v86, v86, v87
    v_add_f32 v88, v88, v89
    v_add_f32 v90, v90, v91
    s_mov_b32 m0, s41
    s_add_u32 s41, s41, 4096
    buffer_load_dwordx4 v2, s[4:7], s40 offen sc1 lds
    s_add_u32 s40, s40, 4096
    ds_read_b64_tr_b16 a[140:141], v208 offset:52224
    ds_read_b64_tr_b16 a[142:143], v209 offset:52224
    s_waitcnt lgkmcnt(8)
    v_mfma_f32_32x32x16_bf16 v[32:47], a[120:123], v[180:183], v[32:47]
    v_add_f32 v92, v92, v93
    v_add_f32 v80, v80, v82
    v_add_f32 v84, v84, v86
    ds_read_b64_tr_b16 a[112:113], v208 offset:24576
    ds_read_b64_tr_b16 a[114:115], v209 offset:24576
    v_mfma_f32_32x32x16_bf16 v[48:63], v[180:183], a[124:127], v[48:63]
    v_add_f32 v88, v88, v90
    v_add_f32 v80, v80, v84
    v_add_f32 v88, v88, v92
    ds_read_b64_tr_b16 a[116:117], v208 offset:53248
    ds_read_b64_tr_b16 a[118:119], v209 offset:53248
    s_waitcnt vmcnt(12) lgkmcnt(8)
    v_mfma_f32_32x32x16_bf16 v[32:47], a[128:131], v[184:187], v[32:47]
    v_add_f32 v80, v80, v88
    v_mul_f32 v80, 0x3b124925, v80
    v_mov_b32 v81, v80
    ds_read_b64_tr_b16 a[120:121], v208 offset:25600
    ds_read_b64_tr_b16 a[122:123], v209 offset:25600
    v_mfma_f32_32x32x16_bf16 v[48:63], v[184:187], a[132:135], v[48:63]
    s_nop 1
    v_permlane32_swap_b32 v80, v81
    v_fma_f32 v82, -v80, v80, v81
    ds_read_b64_tr_b16 a[124:125], v208 offset:54272
    ds_read_b64_tr_b16 a[126:127], v209 offset:54272
    s_waitcnt vmcnt(10) lgkmcnt(8)
    v_mfma_f32_32x32x16_bf16 v[32:47], a[136:139], v[188:191], v[32:47]
    v_max_f32 v82, 0, v82
    v_add_f32 v82, 0x3727c5ac, v82
    v_rsq_f32 v12, v82
    ds_read_b64_tr_b16 a[128:129], v208 offset:26624
    ds_read_b64_tr_b16 a[130:131], v209 offset:26624
    v_mfma_f32_32x32x16_bf16 v[48:63], v[188:191], a[140:143], v[48:63]
    v_sub_f32 v80, 0, v80
    v_cvt_pk_bf16_f32 v83, v80, v80
    v_and_b32 v84, 0xffff0000, v83
    ds_read_b64_tr_b16 a[132:133], v208 offset:55296
    ds_read_b64_tr_b16 a[134:135], v209 offset:55296
    s_waitcnt vmcnt(8) lgkmcnt(8)
    v_mfma_f32_32x32x16_bf16 v[32:47], a[112:115], v[192:195], v[32:47]
    v_sub_f32 v84, v80, v84
    v_cvt_pk_bf16_f32 v84, v84, v84
    v_cndmask_b32 v238, 0, v83, s[20:21]
    ds_read_b64_tr_b16 a[136:137], v208 offset:27648
    ds_read_b64_tr_b16 a[138:139], v209 offset:27648
    v_mfma_f32_32x32x16_bf16 v[48:63], v[192:195], a[116:119], v[48:63]
    v_cndmask_b32 v239, 0, v84, s[20:21]
    ds_read_b64_tr_b16 a[140:141], v208 offset:56320
    ds_read_b64_tr_b16 a[142:143], v209 offset:56320
    s_waitcnt vmcnt(6) lgkmcnt(8)
    s_cbranch_execz L_walk
    v_mfma_f32_32x32x16_bf16 v[32:47], a[120:123], v[196:199], v[32:47]
    s_mul_i32 s16, s3, 19456
    s_add_u32 s16, s16, 103936
    v_add_u32 v14, s16, v4
    ds_write_b32 v14, v12
    v_lshl_add_u32 v14, v5, 4, s16
    v_mfma_f32_32x32x16_bf16 v[48:63], v[196:199], a[124:127], v[48:63]
    s_waitcnt vmcnt(4) lgkmcnt(5)
    v_mfma_f32_32x32x16_bf16 v[32:47], a[128:131], v[200:203], v[32:47]
    v_mfma_f32_32x32x16_bf16 v[48:63], v[200:203], a[132:135], v[48:63]
    s_waitcnt lgkmcnt(0)
    ds_read_b128 v[80:83], v14 offset:0
    ds_read_b128 v[84:87], v14 offset:32
    ds_read_b128 v[88:91], v14 offset:64
    ds_read_b128 v[92:95], v14 offset:96
    s_waitcnt vmcnt(2)
    v_mfma_f32_32x32x16_bf16 v[32:47], a[136:139], v[204:207], v[32:47]
    v_mfma_f32_32x32x16_bf16 v[48:63], v[204:207], a[140:143], v[48:63]
    s_waitcnt vmcnt(0) lgkmcnt(0)
L_qkv2:
    v_add_u32 v208, 57344, v208
    v_add_u32 v209, 57344, v209
    s_add_u32 s12, s64, s31
    v_mov_b32 v13, 0x3f803f80
    v_and_b32 v15, 31, v1
    v_cmp_eq_u32 vcc, 28, v15
    s_nop 3
    v_mfma_f32_32x32x8_bf16 v[32:47], v[226:227], v[238:239], v[32:47]
    v_mfma_f32_32x32x8_bf16 v[48:63], v[238:239], v[228:229], v[48:63]
    v_cndmask_b32 v15, 0, v13, vcc
    s_lshl_b32 s14, s30, 13
    s_lshl_b32 s15, s55, 9
    s_add_u32 s14, s14, s15
    s_lshl_b32 s19, s3, 7
    s_add_u32 s14, s14, s19
    s_add_u32 s14, s14, 2621440
    s_lshl_b32 s24, s54, 3
    s_add_u32 s24, s24, s14
    s_lshl_b32 s15, s9, 9
    s_add_u32 s15, s15, 2637824
    v_pk_mul_f32 v[32:33], v[32:33], v[12:13] op_sel_hi:[1,0]
    v_pk_mul_f32 v[34:35], v[34:35], v[12:13] op_sel_hi:[1,0]
    v_pk_mul_f32 v[36:37], v[36:37], v[12:13] op_sel_hi:[1,0]
    v_pk_mul_f32 v[38:39], v[38:39], v[12:13] op_sel_hi:[1,0]
    v_pk_mul_f32 v[40:41], v[40:41], v[12:13] op_sel_hi:[1,0]
    v_pk_mul_f32 v[42:43], v[42:43], v[12:13] op_sel_hi:[1,0]
    v_pk_mul_f32 v[44:45], v[44:45], v[12:13] op_sel_hi:[1,0]
    v_pk_mul_f32 v[46:47], v[46:47], v[12:13] op_sel_hi:[1,0]
    v_cvt_pk_bf16_f32 v64, v32, v33
    v_cvt_pk_bf16_f32 v65, v34, v35
    v_cvt_pk_bf16_f32 v66, v36, v37
    v_cvt_pk_bf16_f32 v67, v38, v39
    v_cvt_pk_bf16_f32 v68, v40, v41
    v_cvt_pk_bf16_f32 v69, v42, v43
    v_cvt_pk_bf16_f32 v70, v44, v45
    v_cvt_pk_bf16_f32 v71, v46, v47
    v_cndmask_b32 v70, v13, v70, s[20:21]
    v_cndmask_b32 v71, v13, v71, s[20:21]
    buffer_store_dwordx4 v[64:67], v2, s[4:7], s12 offen sc1
    v_pk_mul_f32 v[48:49], v[48:49], v[80:81]
    v_pk_mul_f32 v[50:51], v[50:51], v[82:83]
    v_pk_mul_f32 v[52:53], v[52:53], v[84:85]
    v_pk_mul_f32 v[54:55], v[54:55], v[86:87]
    v_pk_mul_f32 v[56:57], v[56:57], v[88:89]
    v_pk_mul_f32 v[58:59], v[58:59], v[90:91]
    v_pk_mul_f32 v[60:61], v[60:61], v[92:93]
    v_pk_mul_f32 v[62:63], v[62:63], v[94:95]
    buffer_store_dwordx4 v[68:71], v2, s[4:7], s12 offen offset:1024 sc1
    v_cvt_pk_bf16_f32 v72, v48, v49
    v_cvt_pk_bf16_f32 v73, v50, v51
    v_cvt_pk_bf16_f32 v74, v52, v53
    v_cvt_pk_bf16_f32 v75, v54, v55
    v_cndmask_b32 v72, v72, v15, s[22:23]
    s_nop 0
    s_cbranch_execz L_walk
    v_cndmask_b32 v73, v73, v15, s[22:23]
    v_cndmask_b32 v74, v74, v15, s[22:23]
    v_cndmask_b32 v75, v75, v15, s[22:23]
    buffer_store_dwordx4 v[72:75], v2, s[4:7], s12 offen offset:2048 sc1
    v_cvt_pk_bf16_f32 v76, v56, v57
    v_cvt_pk_bf16_f32 v77, v58, v59
    v_cvt_pk_bf16_f32 v78, v60, v61
    v_cvt_pk_bf16_f32 v79, v62, v63
    v_cndmask_b32 v76, v76, v15, s[22:23]
    v_cndmask_b32 v77, v77, v15, s[22:23]
    v_cndmask_b32 v78, v78, v15, s[22:23]
    v_cndmask_b32 v79, v79, v15, s[22:23]
    buffer_store_dwordx4 v[76:79], v2, s[4:7], s12 offen offset:3072 sc1
    s_cmp_eq_u32 s30, 0
    s_cbranch_scc1 L_q0b
    s_barrier
L_q0r:
    v_mfma_f32_32x32x8_bf16 v[16:31], v[224:225], v[238:239], 0
    ds_read_b64_tr_b16 a[112:113], v208 offset:0
    ds_read_b64_tr_b16 a[114:115], v209 offset:0
    ds_read_b64_tr_b16 a[116:117], v208 offset:1024
    ds_read_b64_tr_b16 a[118:119], v209 offset:1024
    ds_read_b64_tr_b16 a[120:121], v208 offset:2048
    ds_read_b64_tr_b16 a[122:123], v209 offset:2048
    ds_read_b64_tr_b16 a[124:125], v208 offset:3072
    ds_read_b64_tr_b16 a[126:127], v209 offset:3072
    ds_read_b64_tr_b16 a[128:129], v208 offset:4096
    ds_read_b64_tr_b16 a[130:131], v209 offset:4096
    ds_read_b64_tr_b16 a[132:133], v208 offset:5120
    ds_read_b64_tr_b16 a[134:135], v209 offset:5120
    s_waitcnt lgkmcnt(8)
    v_mfma_f32_32x32x16_bf16 v[16:31], a[112:115], v[96:99], v[16:31]
    s_mov_b32 s36, s56
    s_mov_b32 s37, s57
    s_mov_b32 s38, 1605632
    s_mov_b32 s39, 0x20000
    ds_read_b64_tr_b16 a[136:137], v208 offset:6144
    ds_read_b64_tr_b16 a[138:139], v209 offset:6144
    v_mfma_f32_32x32x16_bf16 v[16:31], a[116:119], v[100:103], v[16:31]
    s_mov_b32 s40, s75
    s_mul_i32 s41, s3, 14336
    v_mov_b32 v80, v211
    v_add_u32 v81, 27648, v211
    ds_read_b64_tr_b16 a[140:141], v208 offset:7168
    ds_read_b64_tr_b16 a[142:143], v209 offset:7168
    s_waitcnt lgkmcnt(8)
    v_mfma_f32_32x32x16_bf16 v[16:31], a[120:123], v[104:107], v[16:31]
    v_add_u32 v82, 55296, v211
    v_add_u32 v83, 82944, v211
    ds_read_b64_tr_b16 a[112:113], v208 offset:8192
    ds_read_b64_tr_b16 a[114:115], v209 offset:8192
    v_mfma_f32_32x32x16_bf16 v[16:31], a[124:127], v[108:111], v[16:31]
    ds_read_b64_tr_b16 a[116:117], v208 offset:9216
    ds_read_b64_tr_b16 a[118:119], v209 offset:9216
    s_waitcnt lgkmcnt(8)
    v_mfma_f32_32x32x16_bf16 v[16:31], a[128:131], v[112:115], v[16:31]
    s_getreg_b32 s25, hwreg(HW_REG_XCC_ID, 0, 4)
    s_or_b32 s25, s25, s42
    v_mov_b32 v88, s25
    ds_read_b64_tr_b16 a[120:121], v208 offset:10240
    ds_read_b64_tr_b16 a[122:123], v209 offset:10240
    v_mfma_f32_32x32x16_bf16 v[16:31], a[132:135], v[116:119], v[16:31]
    ds_read_b64_tr_b16 a[124:125], v208 offset:11264
    ds_read_b64_tr_b16 a[126:127], v209 offset:11264
    s_waitcnt lgkmcnt(8)
    v_mfma_f32_32x32x16_bf16 v[16:31], a[136:139], v[120:123], v[16:31]
    v_mov_b32 v89, s43
    s_lshl_b32 s25, s9, 3
    s_add_u32 s25, s25, s32
    ds_read_b64_tr_b16 a[128:129], v208 offset:12288
    ds_read_b64_tr_b16 a[130:131], v209 offset:12288
    v_mfma_f32_32x32x16_bf16 v[16:31], a[140:143], v[124:127], v[16:31]
    ds_read_b64_tr_b16 a[132:133], v208 offset:13312
    s_cbranch_execz L_walk
    ds_read_b64_tr_b16 a[134:135], v209 offset:13312
    s_waitcnt lgkmcnt(8)
    v_mfma_f32_32x32x16_bf16 v[16:31], a[112:115], v[128:131], v[16:31]
    v_mul_f32 v14, 0x3e8b97f6, v12
    s_lshl_b32 s16, s3, 11
    ds_read_b64_tr_b16 a[136:137], v208 offset:14336
    ds_read_b64_tr_b16 a[138:139], v209 offset:14336
    v_mfma_f32_32x32x16_bf16 v[16:31], a[116:119], v[132:135], v[16:31]
    ds_read_b64_tr_b16 a[140:141], v208 offset:15360
    ds_read_b64_tr_b16 a[142:143], v209 offset:15360
    s_waitcnt lgkmcnt(8)
    v_mfma_f32_32x32x16_bf16 v[16:31], a[120:123], v[136:139], v[16:31]
    s_add_u32 s16, s16, 147456
    v_add_u32 v13, s16, v2
    ds_read_b64_tr_b16 a[112:113], v208 offset:16384
    ds_read_b64_tr_b16 a[114:115], v209 offset:16384
    v_mfma_f32_32x32x16_bf16 v[16:31], a[124:127], v[140:143], v[16:31]
    ds_read_b64_tr_b16 a[116:117], v208 offset:17408
    ds_read_b64_tr_b16 a[118:119], v209 offset:17408
    s_waitcnt lgkmcnt(8)
    v_mfma_f32_32x32x16_bf16 v[16:31], a[128:131], v[144:147], v[16:31]
    s_add_u32 s16, s78, s31
    s_add_u32 s44, s4, s16
    s_addc_u32 s45, s5, 0
    ds_read_b64_tr_b16 a[120:121], v208 offset:18432
    ds_read_b64_tr_b16 a[122:123], v209 offset:18432
    v_mfma_f32_32x32x16_bf16 v[16:31], a[132:135], v[148:151], v[16:31]
    ds_read_b64_tr_b16 a[124:125], v208 offset:19456
    ds_read_b64_tr_b16 a[126:127], v209 offset:19456
    s_waitcnt lgkmcnt(8)
    v_mfma_f32_32x32x16_bf16 v[16:31], a[136:139], v[152:155], v[16:31]
    s_mov_b32 s46, 0x40000
    s_mov_b32 s47, 0x20000
    s_lshl_b32 s11, s54, 14
    ds_read_b64_tr_b16 a[128:129], v208 offset:20480
    ds_read_b64_tr_b16 a[130:131], v209 offset:20480
    v_mfma_f32_32x32x16_bf16 v[16:31], a[140:143], v[156:159], v[16:31]
    ds_read_b64_tr_b16 a[132:133], v208 offset:21504
    ds_read_b64_tr_b16 a[134:135], v209 offset:21504
    s_waitcnt lgkmcnt(8)
    v_mfma_f32_32x32x16_bf16 v[16:31], a[112:115], v[160:163], v[16:31]
    s_mov_b32 s13, s73
    s_mov_b32 s27, s74
    ds_read_b64_tr_b16 a[136:137], v208 offset:22528
    ds_read_b64_tr_b16 a[138:139], v209 offset:22528
    v_mfma_f32_32x32x16_bf16 v[16:31], a[116:119], v[164:167], v[16:31]
    ds_read_b64_tr_b16 a[140:141], v208 offset:23552
    ds_read_b64_tr_b16 a[142:143], v209 offset:23552
    s_waitcnt lgkmcnt(8)
    v_mfma_f32_32x32x16_bf16 v[16:31], a[120:123], v[168:171], v[16:31]
    v_lshlrev_b32 v85, 3, v1
    v_and_b32 v84, 0x78, v85
    ds_read_b64_tr_b16 a[112:113], v208 offset:24576
    ds_read_b64_tr_b16 a[114:115], v209 offset:24576
    v_mfma_f32_32x32x16_bf16 v[16:31], a[124:127], v[172:175], v[16:31]
    ds_read_b64_tr_b16 a[116:117], v208 offset:25600
    ds_read_b64_tr_b16 a[118:119], v209 offset:25600
    s_waitcnt lgkmcnt(8)
    v_mfma_f32_32x32x16_bf16 v[16:31], a[128:131], v[176:179], v[16:31]
    s_add_u32 s16, s33, 7
    s_cmp_ge_u32 s34, 7
    s_cselect_b32 s16, s33, s16
    ds_read_b64_tr_b16 a[120:121], v208 offset:26624
    ds_read_b64_tr_b16 a[122:123], v209 offset:26624
    v_mfma_f32_32x32x16_bf16 v[16:31], a[132:135], v[180:183], v[16:31]
    ds_read_b64_tr_b16 a[124:125], v208 offset:27648
    ds_read_b64_tr_b16 a[126:127], v209 offset:27648
    s_waitcnt lgkmcnt(8)
    v_mfma_f32_32x32x16_bf16 v[16:31], a[136:139], v[184:187], v[16:31]
    s_lshl_b32 s16, s16, 9
    s_add_u32 s16, s16, 2637824
    s_cmp_eq_u32 s30, 0
    s_cbranch_scc1 L_kf1
    s_waitcnt vmcnt(0)
    s_mov_b64 exec, 1
    buffer_store_dwordx2 v[214:215], off, s[4:7], s24 sc1
    s_cbranch_execz L_walk
L_kf1:
    s_mov_b64 exec, 1
    buffer_store_dwordx2 v[88:89], off, s[4:7], s25 offset:2560 sc1
    s_mov_b64 exec, -1
    v_mfma_f32_32x32x16_bf16 v[16:31], a[140:143], v[188:191], v[16:31]
    s_waitcnt lgkmcnt(4)
    v_mfma_f32_32x32x16_bf16 v[16:31], a[112:115], v[192:195], v[16:31]
    v_mfma_f32_32x32x16_bf16 v[16:31], a[116:119], v[196:199], v[16:31]
    s_waitcnt lgkmcnt(0)
    v_mfma_f32_32x32x16_bf16 v[16:31], a[120:123], v[200:203], v[16:31]
    v_mfma_f32_32x32x16_bf16 v[16:31], a[124:127], v[204:207], v[16:31]
    s_nop 11
    v_cndmask_b32 v28, 0, v28, s[20:21]
    v_cndmask_b32 v29, 0, v29, s[20:21]
    v_cndmask_b32 v30, 0, v30, s[20:21]
    v_cndmask_b32 v31, 0, v31, s[20:21]
    v_pk_mul_f32 v[16:17], v[16:17], v[14:15] op_sel_hi:[1,0]
    v_pk_mul_f32 v[18:19], v[18:19], v[14:15] op_sel_hi:[1,0]
    v_pk_mul_f32 v[20:21], v[20:21], v[14:15] op_sel_hi:[1,0]
    v_pk_mul_f32 v[22:23], v[22:23], v[14:15] op_sel_hi:[1,0]
    v_pk_mul_f32 v[24:25], v[24:25], v[14:15] op_sel_hi:[1,0]
    v_pk_mul_f32 v[26:27], v[26:27], v[14:15] op_sel_hi:[1,0]
    v_pk_mul_f32 v[28:29], v[28:29], v[14:15] op_sel_hi:[1,0]
    v_pk_mul_f32 v[30:31], v[30:31], v[14:15] op_sel_hi:[1,0]
    v_pk_mul_f32 v[238:239], v[16:17], v[32:33]
    v_pk_fma_f32 v[238:239], v[18:19], v[34:35], v[238:239]
    v_pk_fma_f32 v[238:239], v[20:21], v[36:37], v[238:239]
    v_pk_fma_f32 v[238:239], v[22:23], v[38:39], v[238:239]
    v_pk_fma_f32 v[238:239], v[24:25], v[40:41], v[238:239]
    v_pk_fma_f32 v[238:239], v[26:27], v[42:43], v[238:239]
    v_pk_fma_f32 v[238:239], v[28:29], v[44:45], v[238:239]
    v_pk_fma_f32 v[238:239], v[30:31], v[46:47], v[238:239]
    v_add_f32 v238, v238, v239
    v_mov_b32 v239, v238
    v_cvt_pk_bf16_f32 v216, v16, v17
    v_cvt_pk_bf16_f32 v217, v18, v19
    v_cvt_pk_bf16_f32 v218, v20, v21
    v_cvt_pk_bf16_f32 v219, v22, v23
    v_permlane32_swap_b32 v238, v239
    ds_write_b128 v13, v[216:219]
    v_add_f32 v238, v238, v239
    v_sub_f32 v238, 0, v238
    v_cndmask_b32 v28, v238, v28, s[20:21]
    v_cvt_pk_bf16_f32 v220, v24, v25
    v_cvt_pk_bf16_f32 v221, v26, v27
    v_cvt_pk_bf16_f32 v222, v28, v29
    v_cvt_pk_bf16_f32 v223, v30, v31
    ds_write_b128 v13, v[220:223] offset:1024
    s_waitcnt lgkmcnt(0)
    s_barrier
    v_xor_b32 v12, 6144, v13
    ds_read_b128 v[16:19], v12
    ds_read_b128 v[20:23], v12 offset:1024
    v_xor_b32 v12, 4096, v13
    ds_read_b128 v[24:27], v12
    ds_read_b128 v[28:31], v12 offset:1024
    v_xor_b32 v12, 2048, v13
    ds_read_b128 v[32:35], v12
    ds_read_b128 v[36:39], v12 offset:1024
    v_mov_b32 v12, v13
    ds_read_b128 v[40:43], v12
    ds_read_b128 v[44:47], v12 offset:1024
    s_waitcnt lgkmcnt(6)
    v_mfma_f32_32x32x16_bf16 v[112:127], v[64:67], v[16:19], 0
    v_mfma_f32_32x32x16_bf16 v[112:127], v[68:71], v[20:23], v[112:127]
    s_mul_i32 s19, s3, 19456
    s_add_u32 s19, s19, 99840
    v_add_u32 v13, s19, v213
    ds_read_b64_tr_b16 v[88:89], v13 offset:0
    ds_read_b64_tr_b16 v[90:91], v13 offset:1024
    ds_read_b64_tr_b16 v[92:93], v13 offset:512
    ds_read_b64_tr_b16 v[94:95], v13 offset:1536
    s_cbranch_execz L_walk
    ds_read_b64_tr_b16 v[96:97], v13 offset:2048
    ds_read_b64_tr_b16 v[98:99], v13 offset:3072
    ds_read_b64_tr_b16 v[100:101], v13 offset:2560
    ds_read_b64_tr_b16 v[102:103], v13 offset:3584
    s_waitcnt lgkmcnt(0)
    s_barrier
    s_mov_b32 s26, s11
    s_xor_b32 s11, s26, 32768
    s_mov_b32 s12, 0x7fff0000
    s_mov_b32 s19, 0x7fff0000
    s_mov_b32 s28, 0x7fff0000
    s_mov_b32 s29, 0x7fff0000
    s_mov_b32 m0, s41
    s_mov_b32 s41, 0
    s_nop 0
    v_mfma_f32_32x32x16_bf16 v[128:143], v[64:67], v[24:27], 0
    buffer_load_dwordx2 v[14:15], v84, s[4:7], s14 offen sc1
    v_exp_f32 v112, v112
    v_exp_f32 v113, v113
    v_exp_f32 v114, v114
    v_exp_f32 v115, v115
    v_cvt_pk_bf16_f32 v144, v112, v113
    v_exp_f32 v116, v116
    v_mfma_f32_32x32x16_bf16 v[128:143], v[68:71], v[28:31], v[128:143]
    v_exp_f32 v117, v117
    v_cvt_pk_bf16_f32 v145, v114, v115
    v_exp_f32 v118, v118
    v_exp_f32 v119, v119
    v_cvt_pk_bf16_f32 v146, v116, v117
    v_exp_f32 v120, v120
    v_exp_f32 v121, v121
    v_cvt_pk_bf16_f32 v147, v118, v119
    v_exp_f32 v122, v122
    v_exp_f32 v123, v123
    v_cvt_pk_bf16_f32 v148, v120, v121
    v_exp_f32 v124, v124
    v_exp_f32 v125, v125
    v_exp_f32 v126, v126
    v_cvt_pk_bf16_f32 v149, v122, v123
    v_exp_f32 v127, v127
    v_cvt_pk_bf16_f32 v150, v124, v125
    v_cvt_pk_bf16_f32 v151, v126, v127
    v_mfma_f32_32x32x16_bf16 v[112:127], v[64:67], v[32:35], 0
    v_exp_f32 v128, v128
    v_exp_f32 v129, v129
    v_exp_f32 v130, v130
    v_exp_f32 v131, v131
    v_cvt_pk_bf16_f32 v152, v128, v129
    v_exp_f32 v132, v132
    v_mfma_f32_32x32x16_bf16 v[112:127], v[68:71], v[36:39], v[112:127]
    v_exp_f32 v133, v133
    v_cvt_pk_bf16_f32 v153, v130, v131
    v_exp_f32 v134, v134
    v_exp_f32 v135, v135
    v_cvt_pk_bf16_f32 v154, v132, v133
    v_exp_f32 v136, v136
    v_mfma_f32_32x32x16_bf16 v[160:175], v[72:75], v[144:147], 0
    v_exp_f32 v137, v137
    v_cvt_pk_bf16_f32 v155, v134, v135
    v_exp_f32 v138, v138
    v_exp_f32 v139, v139
    v_cvt_pk_bf16_f32 v156, v136, v137
    v_exp_f32 v140, v140
    v_mfma_f32_32x32x16_bf16 v[160:175], v[76:79], v[148:151], v[160:175]
    s_waitcnt vmcnt(0)
    v_cmp_ne_u64 vcc, s[42:43], v[14:15]
    s_cbranch_vccnz L_pl2
L_pb2:
    buffer_load_dwordx4 a[16:19], v2, s[44:47], s11 offen offset:0 sc1
    buffer_load_dwordx4 a[20:23], v2, s[44:47], s11 offen offset:1024 sc1
    v_exp_f32 v141, v141
    v_exp_f32 v142, v142
    v_cvt_pk_bf16_f32 v157, v138, v139
    v_exp_f32 v143, v143
    v_cvt_pk_bf16_f32 v158, v140, v141
    v_cvt_pk_bf16_f32 v159, v142, v143
    v_mfma_f32_32x32x16_bf16 v[128:143], v[64:67], v[40:43], 0
    buffer_load_dwordx4 a[24:27], v2, s[44:47], s11 offen offset:2048 sc1
    v_exp_f32 v112, v112
    v_exp_f32 v113, v113
    v_exp_f32 v114, v114
    v_exp_f32 v115, v115
    v_cvt_pk_bf16_f32 v144, v112, v113
    v_exp_f32 v116, v116
    v_mfma_f32_32x32x16_bf16 v[128:143], v[68:71], v[44:47], v[128:143]
    buffer_load_dwordx4 a[28:31], v2, s[44:47], s11 offen offset:3072 sc1
    s_xor_b32 s11, s26, 49152
    v_exp_f32 v117, v117
    s_cbranch_execz L_walk
    v_cvt_pk_bf16_f32 v145, v114, v115
    v_exp_f32 v118, v118
    v_exp_f32 v119, v119
    v_cvt_pk_bf16_f32 v146, v116, v117
    v_exp_f32 v120, v120
    v_mfma_f32_32x32x16_bf16 v[176:191], v[72:75], v[152:155], 0
    buffer_load_dwordx4 a[32:35], v2, s[44:47], s11 offen offset:0 sc1
    v_exp_f32 v121, v121
    v_cvt_pk_bf16_f32 v147, v118, v119
    v_exp_f32 v122, v122
    v_exp_f32 v123, v123
    v_cvt_pk_bf16_f32 v148, v120, v121
    v_exp_f32 v124, v124
    v_mfma_f32_32x32x16_bf16 v[176:191], v[76:79], v[156:159], v[176:191]
    buffer_load_dwordx4 a[36:39], v2, s[44:47], s11 offen offset:1024 sc1
    v_exp_f32 v125, v125
    v_exp_f32 v126, v126
    v_cvt_pk_bf16_f32 v149, v122, v123
    v_exp_f32 v127, v127
    v_cvt_pk_bf16_f32 v150, v124, v125
    v_cvt_pk_bf16_f32 v151, v126, v127
    v_mfma_f32_32x32x16_bf16 v[192:207], v[72:75], v[144:147], 0
    buffer_load_dwordx4 a[40:43], v2, s[44:47], s11 offen offset:2048 sc1
    v_exp_f32 v128, v128
    v_exp_f32 v129, v129
    v_exp_f32 v130, v130
    v_exp_f32 v131, v131
    v_cvt_pk_bf16_f32 v152, v128, v129
    v_exp_f32 v132, v132
    v_mfma_f32_32x32x16_bf16 v[192:207], v[76:79], v[148:151], v[192:207]
    buffer_load_dwordx4 a[44:47], v2, s[44:47], s11 offen offset:3072 sc1
    v_exp_f32 v133, v133
    v_cvt_pk_bf16_f32 v153, v130, v131
    v_exp_f32 v134, v134
    v_exp_f32 v135, v135
    v_cvt_pk_bf16_f32 v154, v132, v133
    v_exp_f32 v136, v136
    v_exp_f32 v137, v137
    v_cvt_pk_bf16_f32 v155, v134, v135
    v_exp_f32 v138, v138
    v_exp_f32 v139, v139
    v_cvt_pk_bf16_f32 v156, v136, v137
    v_exp_f32 v140, v140
    v_exp_f32 v141, v141
    v_exp_f32 v142, v142
    v_cvt_pk_bf16_f32 v157, v138, v139
    v_exp_f32 v143, v143
    v_cvt_pk_bf16_f32 v158, v140, v141
    v_cvt_pk_bf16_f32 v159, v142, v143
    s_cmp_eq_u32 s30, 0
    s_cbranch_scc1 L_prep
L_prepr:
    s_waitcnt vmcnt(6)
    v_mfma_f32_32x32x16_bf16 v[112:127], a[16:19], v[16:19], 0
    s_xor_b32 s11, s26, 65536
    v_mfma_f32_32x32x16_bf16 v[112:127], a[20:23], v[20:23], v[112:127]
    buffer_load_dwordx4 a[48:51], v2, s[44:47], s11 offen offset:0 sc1
    v_mfma_f32_32x32x16_bf16 v[48:63], v[72:75], v[152:155], 0
    buffer_load_dwordx4 a[52:55], v2, s[44:47], s11 offen offset:1024 sc1
    v_mfma_f32_32x32x16_bf16 v[48:63], v[76:79], v[156:159], v[48:63]
    buffer_load_dwordx4 a[56:59], v2, s[44:47], s11 offen offset:2048 sc1
    s_nop 5
    v_mfma_f32_32x32x16_bf16 v[128:143], a[16:19], v[24:27], 0
    buffer_load_dwordx4 a[60:63], v2, s[44:47], s11 offen offset:3072 sc1
    v_exp_f32 v112, v112
    v_exp_f32 v113, v113
    v_exp_f32 v114, v114
    v_exp_f32 v115, v115
    v_cvt_pk_bf16_f32 v144, v112, v113
    v_exp_f32 v116, v116
    v_mfma_f32_32x32x16_bf16 v[128:143], a[20:23], v[28:31], v[128:143]
    s_xor_b32 s11, s26, 81920
    v_exp_f32 v117, v117
    v_cvt_pk_bf16_f32 v145, v114, v115
    v_exp_f32 v118, v118
    v_exp_f32 v119, v119
    v_cvt_pk_bf16_f32 v146, v116, v117
    v_exp_f32 v120, v120
    v_exp_f32 v121, v121
    v_cvt_pk_bf16_f32 v147, v118, v119
    v_exp_f32 v122, v122
    v_exp_f32 v123, v123
    v_cvt_pk_bf16_f32 v148, v120, v121
    v_exp_f32 v124, v124
    v_exp_f32 v125, v125
    v_exp_f32 v126, v126
    v_cvt_pk_bf16_f32 v149, v122, v123
    s_cbranch_execz L_walk
    v_exp_f32 v127, v127
    v_cvt_pk_bf16_f32 v150, v124, v125
    v_cvt_pk_bf16_f32 v151, v126, v127
    v_mfma_f32_32x32x16_bf16 v[112:127], a[16:19], v[32:35], 0
    buffer_load_dwordx4 a[0:3], v2, s[44:47], s11 offen offset:0 sc1
    v_exp_f32 v128, v128
    v_exp_f32 v129, v129
    v_exp_f32 v130, v130
    v_exp_f32 v131, v131
    v_cvt_pk_bf16_f32 v152, v128, v129
    v_exp_f32 v132, v132
    v_mfma_f32_32x32x16_bf16 v[112:127], a[20:23], v[36:39], v[112:127]
    s_waitcnt vmcnt(9)
    v_exp_f32 v133, v133
    v_cvt_pk_bf16_f32 v153, v130, v131
    v_exp_f32 v134, v134
    v_exp_f32 v135, v135
    v_cvt_pk_bf16_f32 v154, v132, v133
    v_exp_f32 v136, v136
    v_mfma_f32_32x32x16_bf16 v[160:175], a[24:27], v[144:147], v[160:175]
    buffer_load_dwordx4 a[4:7], v2, s[44:47], s11 offen offset:1024 sc1
    v_exp_f32 v137, v137
    v_cvt_pk_bf16_f32 v155, v134, v135
    v_exp_f32 v138, v138
    v_exp_f32 v139, v139
    v_cvt_pk_bf16_f32 v156, v136, v137
    v_exp_f32 v140, v140
    v_mfma_f32_32x32x16_bf16 v[160:175], a[28:31], v[148:151], v[160:175]
    buffer_store_dwordx4 v[88:91], v2, s[4:7], s12 offen offset:0 sc1
    v_exp_f32 v141, v141
    v_exp_f32 v142, v142
    v_cvt_pk_bf16_f32 v157, v138, v139
    v_exp_f32 v143, v143
    v_cvt_pk_bf16_f32 v158, v140, v141
    v_cvt_pk_bf16_f32 v159, v142, v143
    v_mfma_f32_32x32x16_bf16 v[128:143], a[16:19], v[40:43], 0
    buffer_load_dwordx4 a[8:11], v2, s[44:47], s11 offen offset:2048 sc1
    v_exp_f32 v112, v112
    v_exp_f32 v113, v113
    v_exp_f32 v114, v114
    v_exp_f32 v115, v115
    v_cvt_pk_bf16_f32 v144, v112, v113
    v_exp_f32 v116, v116
    v_mfma_f32_32x32x16_bf16 v[128:143], a[20:23], v[44:47], v[128:143]
    buffer_store_dwordx4 v[92:95], v2, s[4:7], s12 offen offset:1024 sc1
    v_exp_f32 v117, v117
    v_cvt_pk_bf16_f32 v145, v114, v115
    v_exp_f32 v118, v118
    v_exp_f32 v119, v119
    v_cvt_pk_bf16_f32 v146, v116, v117
    v_exp_f32 v120, v120
    v_mfma_f32_32x32x16_bf16 v[176:191], a[24:27], v[152:155], v[176:191]
    buffer_load_dwordx4 a[12:15], v2, s[44:47], s11 offen offset:3072 sc1
    v_exp_f32 v121, v121
    v_cvt_pk_bf16_f32 v147, v118, v119
    v_exp_f32 v122, v122
    v_exp_f32 v123, v123
    v_cvt_pk_bf16_f32 v148, v120, v121
    v_exp_f32 v124, v124
    v_mfma_f32_32x32x16_bf16 v[176:191], a[28:31], v[156:159], v[176:191]
    s_waitcnt vmcnt(10)
    v_exp_f32 v125, v125
    v_exp_f32 v126, v126
    v_cvt_pk_bf16_f32 v149, v122, v123
    v_exp_f32 v127, v127
    v_cvt_pk_bf16_f32 v150, v124, v125
    v_cvt_pk_bf16_f32 v151, v126, v127
    v_mfma_f32_32x32x16_bf16 v[112:127], a[32:35], v[16:19], 0
    s_xor_b32 s11, s26, 98304
    v_exp_f32 v128, v128
    v_exp_f32 v129, v129
    v_exp_f32 v130, v130
    v_exp_f32 v131, v131
    v_cvt_pk_bf16_f32 v152, v128, v129
    v_exp_f32 v132, v132
    v_mfma_f32_32x32x16_bf16 v[112:127], a[36:39], v[20:23], v[112:127]
    buffer_store_dwordx4 v[96:99], v2, s[4:7], s19 offen offset:0 sc1
    v_exp_f32 v133, v133
    v_cvt_pk_bf16_f32 v153, v130, v131
    v_exp_f32 v134, v134
    v_exp_f32 v135, v135
    v_cvt_pk_bf16_f32 v154, v132, v133
    v_exp_f32 v136, v136
    v_mfma_f32_32x32x16_bf16 v[192:207], a[24:27], v[144:147], v[192:207]
    v_exp_f32 v137, v137
    v_cvt_pk_bf16_f32 v155, v134, v135
    s_cbranch_execz L_walk
    v_exp_f32 v138, v138
    v_exp_f32 v139, v139
    v_cvt_pk_bf16_f32 v156, v136, v137
    v_exp_f32 v140, v140
    v_mfma_f32_32x32x16_bf16 v[192:207], a[28:31], v[148:151], v[192:207]
    buffer_store_dwordx4 v[100:103], v2, s[4:7], s19 offen offset:1024 sc1
    v_exp_f32 v141, v141
    v_exp_f32 v142, v142
    v_cvt_pk_bf16_f32 v157, v138, v139
    v_exp_f32 v143, v143
    v_cvt_pk_bf16_f32 v158, v140, v141
    v_cvt_pk_bf16_f32 v159, v142, v143
    v_mfma_f32_32x32x16_bf16 v[128:143], a[32:35], v[24:27], 0
    v_exp_f32 v112, v112
    v_exp_f32 v113, v113
    v_exp_f32 v114, v114
    v_exp_f32 v115, v115
    v_cvt_pk_bf16_f32 v144, v112, v113
    v_exp_f32 v116, v116
    v_mfma_f32_32x32x16_bf16 v[128:143], a[36:39], v[28:31], v[128:143]
    buffer_load_dwordx4 a[16:19], v2, s[44:47], s11 offen offset:0 sc1
    v_exp_f32 v117, v117
    v_cvt_pk_bf16_f32 v145, v114, v115
    v_exp_f32 v118, v118
    v_exp_f32 v119, v119
    v_cvt_pk_bf16_f32 v146, v116, v117
    v_exp_f32 v120, v120
    v_mfma_f32_32x32x16_bf16 v[48:63], a[24:27], v[152:155], v[48:63]
    buffer_store_dwordx4 a[96:99], v2, s[4:7], s28 offen sc1
    v_exp_f32 v121, v121
    v_cvt_pk_bf16_f32 v147, v118, v119
    v_exp_f32 v122, v122
    v_exp_f32 v123, v123
    v_cvt_pk_bf16_f32 v148, v120, v121
    v_exp_f32 v124, v124
    v_mfma_f32_32x32x16_bf16 v[48:63], a[28:31], v[156:159], v[48:63]
    buffer_load_dwordx4 a[20:23], v2, s[44:47], s11 offen offset:1024 sc1
    v_exp_f32 v125, v125
    v_exp_f32 v126, v126
    v_cvt_pk_bf16_f32 v149, v122, v123
    v_exp_f32 v127, v127
    v_cvt_pk_bf16_f32 v150, v124, v125
    v_cvt_pk_bf16_f32 v151, v126, v127
    v_mfma_f32_32x32x16_bf16 v[112:127], a[32:35], v[32:35], 0
    v_exp_f32 v128, v128
    v_exp_f32 v129, v129
    v_exp_f32 v130, v130
    v_exp_f32 v131, v131
    v_cvt_pk_bf16_f32 v152, v128, v129
    v_exp_f32 v132, v132
    v_mfma_f32_32x32x16_bf16 v[112:127], a[36:39], v[36:39], v[112:127]
    buffer_load_dwordx4 a[24:27], v2, s[44:47], s11 offen offset:2048 sc1
    v_exp_f32 v133, v133
    v_cvt_pk_bf16_f32 v153, v130, v131
    v_exp_f32 v134, v134
    v_exp_f32 v135, v135
    v_cvt_pk_bf16_f32 v154, v132, v133
    v_exp_f32 v136, v136
    v_mfma_f32_32x32x16_bf16 v[160:175], a[40:43], v[144:147], v[160:175]
    buffer_store_dwordx4 a[100:103], v2, s[4:7], s29 offen sc1
    v_exp_f32 v137, v137
    v_cvt_pk_bf16_f32 v155, v134, v135
    v_exp_f32 v138, v138
    v_exp_f32 v139, v139
    v_cvt_pk_bf16_f32 v156, v136, v137
    v_exp_f32 v140, v140
    v_mfma_f32_32x32x16_bf16 v[160:175], a[44:47], v[148:151], v[160:175]
    buffer_load_dwordx4 a[28:31], v2, s[44:47], s11 offen offset:3072 sc1
    v_exp_f32 v141, v141
    v_exp_f32 v142, v142
    v_cvt_pk_bf16_f32 v157, v138, v139
    v_exp_f32 v143, v143
    v_cvt_pk_bf16_f32 v158, v140, v141
    v_cvt_pk_bf16_f32 v159, v142, v143
    v_mfma_f32_32x32x16_bf16 v[128:143], a[32:35], v[40:43], 0
    v_exp_f32 v112, v112
    v_exp_f32 v113, v113
    v_exp_f32 v114, v114
    v_exp_f32 v115, v115
    v_cvt_pk_bf16_f32 v144, v112, v113
    v_exp_f32 v116, v116
    v_mfma_f32_32x32x16_bf16 v[128:143], a[36:39], v[44:47], v[128:143]
    v_exp_f32 v117, v117
    v_cvt_pk_bf16_f32 v145, v114, v115
    v_exp_f32 v118, v118
    v_exp_f32 v119, v119
    s_nop 0
    s_cbranch_execz L_walk
    v_cvt_pk_bf16_f32 v146, v116, v117
    v_exp_f32 v120, v120
    v_mfma_f32_32x32x16_bf16 v[176:191], a[40:43], v[152:155], v[176:191]
    v_exp_f32 v121, v121
    v_cvt_pk_bf16_f32 v147, v118, v119
    v_exp_f32 v122, v122
    v_exp_f32 v123, v123
    v_cvt_pk_bf16_f32 v148, v120, v121
    v_exp_f32 v124, v124
    v_mfma_f32_32x32x16_bf16 v[176:191], a[44:47], v[156:159], v[176:191]
    s_waitcnt vmcnt(14)
    v_exp_f32 v125, v125
    v_exp_f32 v126, v126
    v_cvt_pk_bf16_f32 v149, v122, v123
    v_exp_f32 v127, v127
    v_cvt_pk_bf16_f32 v150, v124, v125
    v_cvt_pk_bf16_f32 v151, v126, v127
    v_mfma_f32_32x32x16_bf16 v[112:127], a[48:51], v[16:19], 0
    s_xor_b32 s11, s26, 114688
    v_exp_f32 v128, v128
    v_exp_f32 v129, v129
    v_exp_f32 v130, v130
    v_exp_f32 v131, v131
    v_cvt_pk_bf16_f32 v152, v128, v129
    v_exp_f32 v132, v132
    v_mfma_f32_32x32x16_bf16 v[112:127], a[52:55], v[20:23], v[112:127]
    v_exp_f32 v133, v133
    v_cvt_pk_bf16_f32 v153, v130, v131
    v_exp_f32 v134, v134
    v_exp_f32 v135, v135
    v_cvt_pk_bf16_f32 v154, v132, v133
    v_exp_f32 v136, v136
    v_mfma_f32_32x32x16_bf16 v[192:207], a[40:43], v[144:147], v[192:207]
    v_exp_f32 v137, v137
    v_cvt_pk_bf16_f32 v155, v134, v135
    v_exp_f32 v138, v138
    v_exp_f32 v139, v139
    v_cvt_pk_bf16_f32 v156, v136, v137
    v_exp_f32 v140, v140
    v_mfma_f32_32x32x16_bf16 v[192:207], a[44:47], v[148:151], v[192:207]
    v_exp_f32 v141, v141
    v_exp_f32 v142, v142
    v_cvt_pk_bf16_f32 v157, v138, v139
    v_exp_f32 v143, v143
    v_cvt_pk_bf16_f32 v158, v140, v141
    v_cvt_pk_bf16_f32 v159, v142, v143
    v_mfma_f32_32x32x16_bf16 v[128:143], a[48:51], v[24:27], 0
    v_exp_f32 v112, v112
    v_exp_f32 v113, v113
    v_exp_f32 v114, v114
    v_exp_f32 v115, v115
    v_cvt_pk_bf16_f32 v144, v112, v113
    v_exp_f32 v116, v116
    v_mfma_f32_32x32x16_bf16 v[128:143], a[52:55], v[28:31], v[128:143]
    buffer_load_dwordx4 a[32:35], v2, s[44:47], s11 offen offset:0 sc1
    v_exp_f32 v117, v117
    v_cvt_pk_bf16_f32 v145, v114, v115
    v_exp_f32 v118, v118
    v_exp_f32 v119, v119
    v_cvt_pk_bf16_f32 v146, v116, v117
    v_exp_f32 v120, v120
    v_mfma_f32_32x32x16_bf16 v[48:63], a[40:43], v[152:155], v[48:63]
    v_exp_f32 v121, v121
    v_cvt_pk_bf16_f32 v147, v118, v119
    v_exp_f32 v122, v122
    v_exp_f32 v123, v123
    v_cvt_pk_bf16_f32 v148, v120, v121
    v_exp_f32 v124, v124
    v_mfma_f32_32x32x16_bf16 v[48:63], a[44:47], v[156:159], v[48:63]
    buffer_load_dwordx4 a[36:39], v2, s[44:47], s11 offen offset:1024 sc1
    v_exp_f32 v125, v125
    v_exp_f32 v126, v126
    v_cvt_pk_bf16_f32 v149, v122, v123
    v_exp_f32 v127, v127
    v_cvt_pk_bf16_f32 v150, v124, v125
    v_cvt_pk_bf16_f32 v151, v126, v127
    v_mfma_f32_32x32x16_bf16 v[112:127], a[48:51], v[32:35], 0
    v_exp_f32 v128, v128
    v_exp_f32 v129, v129
    v_exp_f32 v130, v130
    v_exp_f32 v131, v131
    v_cvt_pk_bf16_f32 v152, v128, v129
    v_exp_f32 v132, v132
    v_mfma_f32_32x32x16_bf16 v[112:127], a[52:55], v[36:39], v[112:127]
    buffer_load_dwordx4 a[40:43], v2, s[44:47], s11 offen offset:2048 sc1
    v_exp_f32 v133, v133
    v_cvt_pk_bf16_f32 v153, v130, v131
    s_cbranch_execz L_walk
    v_exp_f32 v134, v134
    v_exp_f32 v135, v135
    v_cvt_pk_bf16_f32 v154, v132, v133
    v_exp_f32 v136, v136
    v_mfma_f32_32x32x16_bf16 v[160:175], a[56:59], v[144:147], v[160:175]
    v_exp_f32 v137, v137
    v_cvt_pk_bf16_f32 v155, v134, v135
    v_exp_f32 v138, v138
    v_exp_f32 v139, v139
    v_cvt_pk_bf16_f32 v156, v136, v137
    v_exp_f32 v140, v140
    v_mfma_f32_32x32x16_bf16 v[160:175], a[60:63], v[148:151], v[160:175]
    buffer_load_dwordx4 a[44:47], v2, s[44:47], s11 offen offset:3072 sc1
    v_exp_f32 v141, v141
    v_exp_f32 v142, v142
    v_cvt_pk_bf16_f32 v157, v138, v139
    v_exp_f32 v143, v143
    v_cvt_pk_bf16_f32 v158, v140, v141
    v_cvt_pk_bf16_f32 v159, v142, v143
    v_mfma_f32_32x32x16_bf16 v[128:143], a[48:51], v[40:43], 0
    s_waitcnt vmcnt(5)
    v_exp_f32 v112, v112
    v_exp_f32 v113, v113
    v_exp_f32 v114, v114
    v_exp_f32 v115, v115
    v_cvt_pk_bf16_f32 v144, v112, v113
    v_exp_f32 v116, v116
    v_mfma_f32_32x32x16_bf16 v[128:143], a[52:55], v[44:47], v[128:143]
    s_cmp_eq_u32 s30, 0
    v_exp_f32 v117, v117
    v_cvt_pk_bf16_f32 v145, v114, v115
    v_exp_f32 v118, v118
    v_exp_f32 v119, v119
    v_cvt_pk_bf16_f32 v146, v116, v117
    v_exp_f32 v120, v120
    v_mfma_f32_32x32x16_bf16 v[176:191], a[56:59], v[152:155], v[176:191]
    s_cbranch_scc1 L_pf
L_pfr:
    v_exp_f32 v121, v121
    v_cvt_pk_bf16_f32 v147, v118, v119
    v_exp_f32 v122, v122
    v_exp_f32 v123, v123
    v_cvt_pk_bf16_f32 v148, v120, v121
    v_exp_f32 v124, v124
    v_mfma_f32_32x32x16_bf16 v[176:191], a[60:63], v[156:159], v[176:191]
    v_exp_f32 v125, v125
    v_exp_f32 v126, v126
    v_cvt_pk_bf16_f32 v149, v122, v123
    v_exp_f32 v127, v127
    v_cvt_pk_bf16_f32 v150, v124, v125
    v_cvt_pk_bf16_f32 v151, v126, v127
    v_mfma_f32_32x32x16_bf16 v[112:127], a[0:3], v[16:19], 0
    s_xor_b32 s26, s26, 131072
    v_exp_f32 v128, v128
    v_exp_f32 v129, v129
    v_exp_f32 v130, v130
    v_exp_f32 v131, v131
    v_cvt_pk_bf16_f32 v152, v128, v129
    v_exp_f32 v132, v132
    v_mfma_f32_32x32x16_bf16 v[112:127], a[4:7], v[20:23], v[112:127]
    s_mov_b32 s12, 1
    v_exp_f32 v133, v133
    v_cvt_pk_bf16_f32 v153, v130, v131
    v_exp_f32 v134, v134
    v_exp_f32 v135, v135
    v_cvt_pk_bf16_f32 v154, v132, v133
    v_exp_f32 v136, v136
    v_mfma_f32_32x32x16_bf16 v[192:207], a[56:59], v[144:147], v[192:207]
    s_mov_b32 s19, s75
    v_exp_f32 v137, v137
    v_cvt_pk_bf16_f32 v155, v134, v135
    v_exp_f32 v138, v138
    v_exp_f32 v139, v139
    v_cvt_pk_bf16_f32 v156, v136, v137
    v_exp_f32 v140, v140
    v_mfma_f32_32x32x16_bf16 v[192:207], a[60:63], v[148:151], v[192:207]
    v_exp_f32 v141, v141
    v_exp_f32 v142, v142
    v_cvt_pk_bf16_f32 v157, v138, v139
    v_exp_f32 v143, v143
    v_cvt_pk_bf16_f32 v158, v140, v141
    v_cvt_pk_bf16_f32 v159, v142, v143
L_loop:
    v_mfma_f32_32x32x16_bf16 v[128:143], a[0:3], v[24:27], 0
    s_mov_b32 s11, s26
    v_exp_f32 v112, v112
    v_exp_f32 v113, v113
    v_exp_f32 v114, v114
    v_exp_f32 v115, v115
    v_cvt_pk_bf16_f32 v144, v112, v113
    v_exp_f32 v116, v116
    v_mfma_f32_32x32x16_bf16 v[128:143], a[4:7], v[28:31], v[128:143]
    s_cbranch_execz L_walk
    buffer_load_dwordx4 a[48:51], v2, s[44:47], s11 offen offset:0 sc1
    v_exp_f32 v117, v117
    v_cvt_pk_bf16_f32 v145, v114, v115
    v_exp_f32 v118, v118
    v_exp_f32 v119, v119
    v_cvt_pk_bf16_f32 v146, v116, v117
    v_exp_f32 v120, v120
    v_mfma_f32_32x32x16_bf16 v[48:63], a[56:59], v[152:155], v[48:63]
    s_add_u32 m0, m0, s41
    v_exp_f32 v121, v121
    v_cvt_pk_bf16_f32 v147, v118, v119
    v_exp_f32 v122, v122
    v_exp_f32 v123, v123
    v_cvt_pk_bf16_f32 v148, v120, v121
    v_exp_f32 v124, v124
    v_mfma_f32_32x32x16_bf16 v[48:63], a[60:63], v[156:159], v[48:63]
    buffer_load_dwordx4 a[52:55], v2, s[44:47], s11 offen offset:1024 sc1
    v_exp_f32 v125, v125
    v_exp_f32 v126, v126
    v_cvt_pk_bf16_f32 v149, v122, v123
    v_exp_f32 v127, v127
    v_cvt_pk_bf16_f32 v150, v124, v125
    v_cvt_pk_bf16_f32 v151, v126, v127
    v_mfma_f32_32x32x16_bf16 v[112:127], a[0:3], v[32:35], 0
    s_mov_b32 s40, s19
    v_exp_f32 v128, v128
    v_exp_f32 v129, v129
    v_exp_f32 v130, v130
    v_exp_f32 v131, v131
    v_cvt_pk_bf16_f32 v152, v128, v129
    v_exp_f32 v132, v132
    v_mfma_f32_32x32x16_bf16 v[112:127], a[4:7], v[36:39], v[112:127]
    buffer_load_dwordx4 a[56:59], v2, s[44:47], s11 offen offset:2048 sc1
    v_exp_f32 v133, v133
    v_cvt_pk_bf16_f32 v153, v130, v131
    v_exp_f32 v134, v134
    v_exp_f32 v135, v135
    v_cvt_pk_bf16_f32 v154, v132, v133
    v_exp_f32 v136, v136
    v_mfma_f32_32x32x16_bf16 v[160:175], a[8:11], v[144:147], v[160:175]
    s_mov_b32 s41, 45056
    v_exp_f32 v137, v137
    v_cvt_pk_bf16_f32 v155, v134, v135
    v_exp_f32 v138, v138
    v_exp_f32 v139, v139
    v_cvt_pk_bf16_f32 v156, v136, v137
    v_exp_f32 v140, v140
    v_mfma_f32_32x32x16_bf16 v[160:175], a[12:15], v[148:151], v[160:175]
    buffer_load_dwordx4 a[60:63], v2, s[44:47], s11 offen offset:3072 sc1
    v_exp_f32 v141, v141
    v_exp_f32 v142, v142
    v_cvt_pk_bf16_f32 v157, v138, v139
    v_exp_f32 v143, v143
    v_cvt_pk_bf16_f32 v158, v140, v141
    v_cvt_pk_bf16_f32 v159, v142, v143
    v_mfma_f32_32x32x16_bf16 v[128:143], a[0:3], v[40:43], 0
    buffer_load_dwordx4 v80, s[36:39], s40 offen offset:0 lds
    v_exp_f32 v112, v112
    v_exp_f32 v113, v113
    v_exp_f32 v114, v114
    v_exp_f32 v115, v115
    v_cvt_pk_bf16_f32 v144, v112, v113
    v_exp_f32 v116, v116
    v_mfma_f32_32x32x16_bf16 v[128:143], a[4:7], v[44:47], v[128:143]
    v_exp_f32 v117, v117
    v_cvt_pk_bf16_f32 v145, v114, v115
    v_exp_f32 v118, v118
    v_exp_f32 v119, v119
    v_cvt_pk_bf16_f32 v146, v116, v117
    v_exp_f32 v120, v120
    v_mfma_f32_32x32x16_bf16 v[176:191], a[8:11], v[152:155], v[176:191]
    buffer_load_dwordx4 v81, s[36:39], s40 offen offset:1024 lds
    v_exp_f32 v121, v121
    v_cvt_pk_bf16_f32 v147, v118, v119
    v_exp_f32 v122, v122
    v_exp_f32 v123, v123
    v_cvt_pk_bf16_f32 v148, v120, v121
    v_exp_f32 v124, v124
    v_mfma_f32_32x32x16_bf16 v[176:191], a[12:15], v[156:159], v[176:191]
    s_waitcnt vmcnt(10)
    v_exp_f32 v125, v125
    v_exp_f32 v126, v126
    v_cvt_pk_bf16_f32 v149, v122, v123
    v_exp_f32 v127, v127
    v_cvt_pk_bf16_f32 v150, v124, v125
    v_cvt_pk_bf16_f32 v151, v126, v127
    s_nop 0
    s_cbranch_execz L_walk
    v_mfma_f32_32x32x16_bf16 v[112:127], a[16:19], v[16:19], 0
    v_exp_f32 v128, v128
    v_exp_f32 v129, v129
    v_exp_f32 v130, v130
    v_exp_f32 v131, v131
    v_cvt_pk_bf16_f32 v152, v128, v129
    v_exp_f32 v132, v132
    v_mfma_f32_32x32x16_bf16 v[112:127], a[20:23], v[20:23], v[112:127]
    buffer_load_dwordx4 v82, s[36:39], s40 offen offset:2048 lds
    v_exp_f32 v133, v133
    v_cvt_pk_bf16_f32 v153, v130, v131
    v_exp_f32 v134, v134
    v_exp_f32 v135, v135
    v_cvt_pk_bf16_f32 v154, v132, v133
    v_exp_f32 v136, v136
    v_mfma_f32_32x32x16_bf16 v[192:207], a[8:11], v[144:147], v[192:207]
    v_exp_f32 v137, v137
    v_cvt_pk_bf16_f32 v155, v134, v135
    v_exp_f32 v138, v138
    v_exp_f32 v139, v139
    v_cvt_pk_bf16_f32 v156, v136, v137
    v_exp_f32 v140, v140
    v_mfma_f32_32x32x16_bf16 v[192:207], a[12:15], v[148:151], v[192:207]
    buffer_load_dwordx4 v83, s[36:39], s40 offen offset:3072 lds
    v_exp_f32 v141, v141
    v_exp_f32 v142, v142
    v_cvt_pk_bf16_f32 v157, v138, v139
    v_exp_f32 v143, v143
    v_cvt_pk_bf16_f32 v158, v140, v141
    v_cvt_pk_bf16_f32 v159, v142, v143
    v_mfma_f32_32x32x16_bf16 v[128:143], a[16:19], v[24:27], 0
    s_xor_b32 s11, s26, 16384
    v_exp_f32 v112, v112
    v_exp_f32 v113, v113
    v_exp_f32 v114, v114
    v_exp_f32 v115, v115
    v_cvt_pk_bf16_f32 v144, v112, v113
    v_exp_f32 v116, v116
    v_mfma_f32_32x32x16_bf16 v[128:143], a[20:23], v[28:31], v[128:143]
    buffer_load_dwordx4 a[0:3], v2, s[44:47], s11 offen offset:0 sc1
    v_exp_f32 v117, v117
    v_cvt_pk_bf16_f32 v145, v114, v115
    v_exp_f32 v118, v118
    v_exp_f32 v119, v119
    v_cvt_pk_bf16_f32 v146, v116, v117
    v_exp_f32 v120, v120
    v_mfma_f32_32x32x16_bf16 v[48:63], a[8:11], v[152:155], v[48:63]
    s_add_u32 m0, m0, 4096
    v_exp_f32 v121, v121
    v_cvt_pk_bf16_f32 v147, v118, v119
    v_exp_f32 v122, v122
    v_exp_f32 v123, v123
    v_cvt_pk_bf16_f32 v148, v120, v121
    v_exp_f32 v124, v124
    v_mfma_f32_32x32x16_bf16 v[48:63], a[12:15], v[156:159], v[48:63]
    buffer_load_dwordx4 a[4:7], v2, s[44:47], s11 offen offset:1024 sc1
    v_exp_f32 v125, v125
    v_exp_f32 v126, v126
    v_cvt_pk_bf16_f32 v149, v122, v123
    v_exp_f32 v127, v127
    v_cvt_pk_bf16_f32 v150, v124, v125
    v_cvt_pk_bf16_f32 v151, v126, v127
    v_mfma_f32_32x32x16_bf16 v[112:127], a[16:19], v[32:35], 0
    s_add_u32 s40, s40, 114688
    v_exp_f32 v128, v128
    v_exp_f32 v129, v129
    v_exp_f32 v130, v130
    v_exp_f32 v131, v131
    v_cvt_pk_bf16_f32 v152, v128, v129
    v_exp_f32 v132, v132
    v_mfma_f32_32x32x16_bf16 v[112:127], a[20:23], v[36:39], v[112:127]
    buffer_load_dwordx4 a[8:11], v2, s[44:47], s11 offen offset:2048 sc1
    v_exp_f32 v133, v133
    v_cvt_pk_bf16_f32 v153, v130, v131
    v_exp_f32 v134, v134
    v_exp_f32 v135, v135
    v_cvt_pk_bf16_f32 v154, v132, v133
    v_exp_f32 v136, v136
    v_mfma_f32_32x32x16_bf16 v[160:175], a[24:27], v[144:147], v[160:175]
    s_add_u32 s19, s19, 1792
    v_exp_f32 v137, v137
    v_cvt_pk_bf16_f32 v155, v134, v135
    v_exp_f32 v138, v138
    v_exp_f32 v139, v139
    v_cvt_pk_bf16_f32 v156, v136, v137
    v_exp_f32 v140, v140
    s_cbranch_execz L_walk
    v_mfma_f32_32x32x16_bf16 v[160:175], a[28:31], v[148:151], v[160:175]
    buffer_load_dwordx4 a[12:15], v2, s[44:47], s11 offen offset:3072 sc1
    v_exp_f32 v141, v141
    v_exp_f32 v142, v142
    v_cvt_pk_bf16_f32 v157, v138, v139
    v_exp_f32 v143, v143
    v_cvt_pk_bf16_f32 v158, v140, v141
    v_cvt_pk_bf16_f32 v159, v142, v143
    v_mfma_f32_32x32x16_bf16 v[128:143], a[16:19], v[40:43], 0
    buffer_load_dwordx4 v80, s[36:39], s40 offen offset:0 lds
    v_exp_f32 v112, v112
    v_exp_f32 v113, v113
    v_exp_f32 v114, v114
    v_exp_f32 v115, v115
    v_cvt_pk_bf16_f32 v144, v112, v113
    v_exp_f32 v116, v116
    v_mfma_f32_32x32x16_bf16 v[128:143], a[20:23], v[44:47], v[128:143]
    v_exp_f32 v117, v117
    v_cvt_pk_bf16_f32 v145, v114, v115
    v_exp_f32 v118, v118
    v_exp_f32 v119, v119
    v_cvt_pk_bf16_f32 v146, v116, v117
    v_exp_f32 v120, v120
    v_mfma_f32_32x32x16_bf16 v[176:191], a[24:27], v[152:155], v[176:191]
    buffer_load_dwordx4 v81, s[36:39], s40 offen offset:1024 lds
    v_exp_f32 v121, v121
    v_cvt_pk_bf16_f32 v147, v118, v119
    v_exp_f32 v122, v122
    v_exp_f32 v123, v123
    v_cvt_pk_bf16_f32 v148, v120, v121
    v_exp_f32 v124, v124
    v_mfma_f32_32x32x16_bf16 v[176:191], a[28:31], v[156:159], v[176:191]
    s_waitcnt vmcnt(14)
    v_exp_f32 v125, v125
    v_exp_f32 v126, v126
    v_cvt_pk_bf16_f32 v149, v122, v123
    v_exp_f32 v127, v127
    v_cvt_pk_bf16_f32 v150, v124, v125
    v_cvt_pk_bf16_f32 v151, v126, v127
    v_mfma_f32_32x32x16_bf16 v[112:127], a[32:35], v[16:19], 0
    v_exp_f32 v128, v128
    v_exp_f32 v129, v129
    v_exp_f32 v130, v130
    v_exp_f32 v131, v131
    v_cvt_pk_bf16_f32 v152, v128, v129
    v_exp_f32 v132, v132
    v_mfma_f32_32x32x16_bf16 v[112:127], a[36:39], v[20:23], v[112:127]
    buffer_load_dwordx4 v82, s[36:39], s40 offen offset:2048 lds
    v_exp_f32 v133, v133
    v_cvt_pk_bf16_f32 v153, v130, v131
    v_exp_f32 v134, v134
    v_exp_f32 v135, v135
    v_cvt_pk_bf16_f32 v154, v132, v133
    v_exp_f32 v136, v136
    v_mfma_f32_32x32x16_bf16 v[192:207], a[24:27], v[144:147], v[192:207]
    v_exp_f32 v137, v137
    v_cvt_pk_bf16_f32 v155, v134, v135
    v_exp_f32 v138, v138
    v_exp_f32 v139, v139
    v_cvt_pk_bf16_f32 v156, v136, v137
    v_exp_f32 v140, v140
    v_mfma_f32_32x32x16_bf16 v[192:207], a[28:31], v[148:151], v[192:207]
    buffer_load_dwordx4 v83, s[36:39], s40 offen offset:3072 lds
    v_exp_f32 v141, v141
    v_exp_f32 v142, v142
    v_cvt_pk_bf16_f32 v157, v138, v139
    v_exp_f32 v143, v143
    v_cvt_pk_bf16_f32 v158, v140, v141
    v_cvt_pk_bf16_f32 v159, v142, v143
    v_mfma_f32_32x32x16_bf16 v[128:143], a[32:35], v[24:27], 0
    s_xor_b32 s11, s26, 32768
    v_exp_f32 v112, v112
    v_exp_f32 v113, v113
    v_exp_f32 v114, v114
    v_exp_f32 v115, v115
    v_cvt_pk_bf16_f32 v144, v112, v113
    v_exp_f32 v116, v116
    v_mfma_f32_32x32x16_bf16 v[128:143], a[36:39], v[28:31], v[128:143]
    buffer_load_dwordx4 a[16:19], v2, s[44:47], s11 offen offset:0 sc1
    v_exp_f32 v117, v117
    v_cvt_pk_bf16_f32 v145, v114, v115
    v_exp_f32 v118, v118
    v_exp_f32 v119, v119
    v_cvt_pk_bf16_f32 v146, v116, v117
    v_exp_f32 v120, v120
    v_mfma_f32_32x32x16_bf16 v[48:63], a[24:27], v[152:155], v[48:63]
    s_cbranch_execz L_walk
    s_add_u32 m0, m0, 4096
    v_exp_f32 v121, v121
    v_cvt_pk_bf16_f32 v147, v118, v119
    v_exp_f32 v122, v122
    v_exp_f32 v123, v123
    v_cvt_pk_bf16_f32 v148, v120, v121
    v_exp_f32 v124, v124
    v_mfma_f32_32x32x16_bf16 v[48:63], a[28:31], v[156:159], v[48:63]
    buffer_load_dwordx4 a[20:23], v2, s[44:47], s11 offen offset:1024 sc1
    v_exp_f32 v125, v125
    v_exp_f32 v126, v126
    v_cvt_pk_bf16_f32 v149, v122, v123
    v_exp_f32 v127, v127
    v_cvt_pk_bf16_f32 v150, v124, v125
    v_cvt_pk_bf16_f32 v151, v126, v127
    v_mfma_f32_32x32x16_bf16 v[112:127], a[32:35], v[32:35], 0
    s_add_u32 s40, s40, 114688
    v_exp_f32 v128, v128
    v_exp_f32 v129, v129
    v_exp_f32 v130, v130
    v_exp_f32 v131, v131
    v_cvt_pk_bf16_f32 v152, v128, v129
    v_exp_f32 v132, v132
    v_mfma_f32_32x32x16_bf16 v[112:127], a[36:39], v[36:39], v[112:127]
    buffer_load_dwordx4 a[24:27], v2, s[44:47], s11 offen offset:2048 sc1
    v_exp_f32 v133, v133
    v_cvt_pk_bf16_f32 v153, v130, v131
    v_exp_f32 v134, v134
    v_exp_f32 v135, v135
    v_cvt_pk_bf16_f32 v154, v132, v133
    v_exp_f32 v136, v136
    v_mfma_f32_32x32x16_bf16 v[160:175], a[40:43], v[144:147], v[160:175]
    v_exp_f32 v137, v137
    v_cvt_pk_bf16_f32 v155, v134, v135
    v_exp_f32 v138, v138
    v_exp_f32 v139, v139
    v_cvt_pk_bf16_f32 v156, v136, v137
    v_exp_f32 v140, v140
    v_mfma_f32_32x32x16_bf16 v[160:175], a[44:47], v[148:151], v[160:175]
    buffer_load_dwordx4 a[28:31], v2, s[44:47], s11 offen offset:3072 sc1
    v_exp_f32 v141, v141
    v_exp_f32 v142, v142
    v_cvt_pk_bf16_f32 v157, v138, v139
    v_exp_f32 v143, v143
    v_cvt_pk_bf16_f32 v158, v140, v141
    v_cvt_pk_bf16_f32 v159, v142, v143
    v_mfma_f32_32x32x16_bf16 v[128:143], a[32:35], v[40:43], 0
    buffer_load_dwordx4 v80, s[36:39], s40 offen offset:0 lds
    v_exp_f32 v112, v112
    v_exp_f32 v113, v113
    v_exp_f32 v114, v114
    v_exp_f32 v115, v115
    v_cvt_pk_bf16_f32 v144, v112, v113
    v_exp_f32 v116, v116
    v_mfma_f32_32x32x16_bf16 v[128:143], a[36:39], v[44:47], v[128:143]
    v_exp_f32 v117, v117
    v_cvt_pk_bf16_f32 v145, v114, v115
    v_exp_f32 v118, v118
    v_exp_f32 v119, v119
    v_cvt_pk_bf16_f32 v146, v116, v117
    v_exp_f32 v120, v120
    v_mfma_f32_32x32x16_bf16 v[176:191], a[40:43], v[152:155], v[176:191]
    buffer_load_dwordx4 v81, s[36:39], s40 offen offset:1024 lds
    v_exp_f32 v121, v121
    v_cvt_pk_bf16_f32 v147, v118, v119
    v_exp_f32 v122, v122
    v_exp_f32 v123, v123
    v_cvt_pk_bf16_f32 v148, v120, v121
    v_exp_f32 v124, v124
    v_mfma_f32_32x32x16_bf16 v[176:191], a[44:47], v[156:159], v[176:191]
    s_waitcnt vmcnt(18)
    v_exp_f32 v125, v125
    v_exp_f32 v126, v126
    v_cvt_pk_bf16_f32 v149, v122, v123
    v_exp_f32 v127, v127
    v_cvt_pk_bf16_f32 v150, v124, v125
    v_cvt_pk_bf16_f32 v151, v126, v127
    v_mfma_f32_32x32x16_bf16 v[112:127], a[48:51], v[16:19], 0
    v_exp_f32 v128, v128
    v_exp_f32 v129, v129
    v_exp_f32 v130, v130
    v_exp_f32 v131, v131
    v_cvt_pk_bf16_f32 v152, v128, v129
    v_exp_f32 v132, v132
    v_mfma_f32_32x32x16_bf16 v[112:127], a[52:55], v[20:23], v[112:127]
    buffer_load_dwordx4 v82, s[36:39], s40 offen offset:2048 lds
    s_cbranch_execz L_walk
    v_exp_f32 v133, v133
    v_cvt_pk_bf16_f32 v153, v130, v131
    v_exp_f32 v134, v134
    v_exp_f32 v135, v135
    v_cvt_pk_bf16_f32 v154, v132, v133
    v_exp_f32 v136, v136
    v_mfma_f32_32x32x16_bf16 v[192:207], a[40:43], v[144:147], v[192:207]
    v_exp_f32 v137, v137
    v_cvt_pk_bf16_f32 v155, v134, v135
    v_exp_f32 v138, v138
    v_exp_f32 v139, v139
    v_cvt_pk_bf16_f32 v156, v136, v137
    v_exp_f32 v140, v140
    v_mfma_f32_32x32x16_bf16 v[192:207], a[44:47], v[148:151], v[192:207]
    buffer_load_dwordx4 v83, s[36:39], s40 offen offset:3072 lds
    v_exp_f32 v141, v141
    v_exp_f32 v142, v142
    v_cvt_pk_bf16_f32 v157, v138, v139
    v_exp_f32 v143, v143
    v_cvt_pk_bf16_f32 v158, v140, v141
    v_cvt_pk_bf16_f32 v159, v142, v143
    v_mfma_f32_32x32x16_bf16 v[128:143], a[48:51], v[24:27], 0
    s_xor_b32 s11, s26, 49152
    v_exp_f32 v112, v112
    v_exp_f32 v113, v113
    v_exp_f32 v114, v114
    v_exp_f32 v115, v115
    v_cvt_pk_bf16_f32 v144, v112, v113
    v_exp_f32 v116, v116
    v_mfma_f32_32x32x16_bf16 v[128:143], a[52:55], v[28:31], v[128:143]
    buffer_load_dwordx4 a[32:35], v2, s[44:47], s11 offen offset:0 sc1
    v_exp_f32 v117, v117
    v_cvt_pk_bf16_f32 v145, v114, v115
    v_exp_f32 v118, v118
    v_exp_f32 v119, v119
    v_cvt_pk_bf16_f32 v146, v116, v117
    v_exp_f32 v120, v120
    v_mfma_f32_32x32x16_bf16 v[48:63], a[40:43], v[152:155], v[48:63]
    s_add_u32 m0, m0, 4096
    v_exp_f32 v121, v121
    v_cvt_pk_bf16_f32 v147, v118, v119
    v_exp_f32 v122, v122
    v_exp_f32 v123, v123
    v_cvt_pk_bf16_f32 v148, v120, v121
    v_exp_f32 v124, v124
    v_mfma_f32_32x32x16_bf16 v[48:63], a[44:47], v[156:159], v[48:63]
    buffer_load_dwordx4 a[36:39], v2, s[44:47], s11 offen offset:1024 sc1
    v_exp_f32 v125, v125
    v_exp_f32 v126, v126
    v_cvt_pk_bf16_f32 v149, v122, v123
    v_exp_f32 v127, v127
    v_cvt_pk_bf16_f32 v150, v124, v125
    v_cvt_pk_bf16_f32 v151, v126, v127
    v_mfma_f32_32x32x16_bf16 v[112:127], a[48:51], v[32:35], 0
    s_add_u32 s40, s40, 114688
    v_exp_f32 v128, v128
    v_exp_f32 v129, v129
    v_exp_f32 v130, v130
    v_exp_f32 v131, v131
    v_cvt_pk_bf16_f32 v152, v128, v129
    v_exp_f32 v132, v132
    v_mfma_f32_32x32x16_bf16 v[112:127], a[52:55], v[36:39], v[112:127]
    buffer_load_dwordx4 a[40:43], v2, s[44:47], s11 offen offset:2048 sc1
    v_exp_f32 v133, v133
    v_cvt_pk_bf16_f32 v153, v130, v131
    v_exp_f32 v134, v134
    v_exp_f32 v135, v135
    v_cvt_pk_bf16_f32 v154, v132, v133
    v_exp_f32 v136, v136
    v_mfma_f32_32x32x16_bf16 v[160:175], a[56:59], v[144:147], v[160:175]
    s_xor_b32 s26, s26, 65536
    v_exp_f32 v137, v137
    v_cvt_pk_bf16_f32 v155, v134, v135
    v_exp_f32 v138, v138
    v_exp_f32 v139, v139
    v_cvt_pk_bf16_f32 v156, v136, v137
    v_exp_f32 v140, v140
    v_mfma_f32_32x32x16_bf16 v[160:175], a[60:63], v[148:151], v[160:175]
    buffer_load_dwordx4 a[44:47], v2, s[44:47], s11 offen offset:3072 sc1
    v_exp_f32 v141, v141
    v_exp_f32 v142, v142
    v_cvt_pk_bf16_f32 v157, v138, v139
    v_exp_f32 v143, v143
    v_cvt_pk_bf16_f32 v158, v140, v141
    v_cvt_pk_bf16_f32 v159, v142, v143
    s_cbranch_execz L_walk
    v_mfma_f32_32x32x16_bf16 v[128:143], a[48:51], v[40:43], 0
    buffer_load_dwordx4 v80, s[36:39], s40 offen offset:0 lds
    v_exp_f32 v112, v112
    v_exp_f32 v113, v113
    v_exp_f32 v114, v114
    v_exp_f32 v115, v115
    v_cvt_pk_bf16_f32 v144, v112, v113
    v_exp_f32 v116, v116
    v_mfma_f32_32x32x16_bf16 v[128:143], a[52:55], v[44:47], v[128:143]
    v_exp_f32 v117, v117
    v_cvt_pk_bf16_f32 v145, v114, v115
    v_exp_f32 v118, v118
    v_exp_f32 v119, v119
    v_cvt_pk_bf16_f32 v146, v116, v117
    v_exp_f32 v120, v120
    v_mfma_f32_32x32x16_bf16 v[176:191], a[56:59], v[152:155], v[176:191]
    buffer_load_dwordx4 v81, s[36:39], s40 offen offset:1024 lds
    v_exp_f32 v121, v121
    v_cvt_pk_bf16_f32 v147, v118, v119
    v_exp_f32 v122, v122
    v_exp_f32 v123, v123
    v_cvt_pk_bf16_f32 v148, v120, v121
    v_exp_f32 v124, v124
    v_mfma_f32_32x32x16_bf16 v[176:191], a[60:63], v[156:159], v[176:191]
    s_waitcnt vmcnt(18)
    v_exp_f32 v125, v125
    v_exp_f32 v126, v126
    v_cvt_pk_bf16_f32 v149, v122, v123
    v_exp_f32 v127, v127
    v_cvt_pk_bf16_f32 v150, v124, v125
    v_cvt_pk_bf16_f32 v151, v126, v127
    v_mfma_f32_32x32x16_bf16 v[112:127], a[0:3], v[16:19], 0
    buffer_load_dwordx2 v[14:15], v85, s[4:7], s15 offen sc1
    v_exp_f32 v128, v128
    v_exp_f32 v129, v129
    v_exp_f32 v130, v130
    v_exp_f32 v131, v131
    v_cvt_pk_bf16_f32 v152, v128, v129
    v_exp_f32 v132, v132
    v_mfma_f32_32x32x16_bf16 v[112:127], a[4:7], v[20:23], v[112:127]
    buffer_load_dwordx2 v[12:13], v85, s[4:7], s16 offen sc1
    v_exp_f32 v133, v133
    v_cvt_pk_bf16_f32 v153, v130, v131
    v_exp_f32 v134, v134
    v_exp_f32 v135, v135
    v_cvt_pk_bf16_f32 v154, v132, v133
    v_exp_f32 v136, v136
    v_mfma_f32_32x32x16_bf16 v[192:207], a[56:59], v[144:147], v[192:207]
    v_exp_f32 v137, v137
    v_cvt_pk_bf16_f32 v155, v134, v135
    v_exp_f32 v138, v138
    v_exp_f32 v139, v139
    v_cvt_pk_bf16_f32 v156, v136, v137
    v_exp_f32 v140, v140
    v_mfma_f32_32x32x16_bf16 v[192:207], a[60:63], v[148:151], v[192:207]
    s_sub_u32 s12, s12, 1
    v_exp_f32 v141, v141
    v_exp_f32 v142, v142
    v_cvt_pk_bf16_f32 v157, v138, v139
    v_exp_f32 v143, v143
    v_cvt_pk_bf16_f32 v158, v140, v141
    v_cvt_pk_bf16_f32 v159, v142, v143
    s_cbranch_scc0 L_loop
    s_cmp_eq_u32 s30, 0
    s_cbranch_scc1 L_tail0
    v_mfma_f32_32x32x16_bf16 v[128:143], a[0:3], v[24:27], 0
    s_xor_b32 s11, s26, 147456
    v_exp_f32 v112, v112
    v_exp_f32 v113, v113
    v_exp_f32 v114, v114
    v_exp_f32 v115, v115
    v_cvt_pk_bf16_f32 v144, v112, v113
    v_exp_f32 v116, v116
    v_mfma_f32_32x32x16_bf16 v[128:143], a[4:7], v[28:31], v[128:143]
    buffer_load_dwordx4 a[48:51], v2, s[44:47], s11 offen offset:0 sc1
    v_exp_f32 v117, v117
    v_cvt_pk_bf16_f32 v145, v114, v115
    v_exp_f32 v118, v118
    v_exp_f32 v119, v119
    v_cvt_pk_bf16_f32 v146, v116, v117
    v_exp_f32 v120, v120
    v_mfma_f32_32x32x16_bf16 v[48:63], a[56:59], v[152:155], v[48:63]
    v_exp_f32 v121, v121
    v_cvt_pk_bf16_f32 v147, v118, v119
    v_exp_f32 v122, v122
    v_exp_f32 v123, v123
    v_cvt_pk_bf16_f32 v148, v120, v121
    v_exp_f32 v124, v124
    s_nop 0
    s_cbranch_execz L_walk
    v_mfma_f32_32x32x16_bf16 v[48:63], a[60:63], v[156:159], v[48:63]
    buffer_load_dwordx4 a[52:55], v2, s[44:47], s11 offen offset:1024 sc1
    v_exp_f32 v125, v125
    v_exp_f32 v126, v126
    v_cvt_pk_bf16_f32 v149, v122, v123
    v_exp_f32 v127, v127
    v_cvt_pk_bf16_f32 v150, v124, v125
    v_cvt_pk_bf16_f32 v151, v126, v127
    v_mfma_f32_32x32x16_bf16 v[112:127], a[0:3], v[32:35], 0
    v_exp_f32 v128, v128
    v_exp_f32 v129, v129
    v_exp_f32 v130, v130
    v_exp_f32 v131, v131
    v_cvt_pk_bf16_f32 v152, v128, v129
    v_exp_f32 v132, v132
    v_mfma_f32_32x32x16_bf16 v[112:127], a[4:7], v[36:39], v[112:127]
    buffer_load_dwordx4 a[56:59], v2, s[44:47], s11 offen offset:2048 sc1
    v_exp_f32 v133, v133
    v_cvt_pk_bf16_f32 v153, v130, v131
    v_exp_f32 v134, v134
    v_exp_f32 v135, v135
    v_cvt_pk_bf16_f32 v154, v132, v133
    v_exp_f32 v136, v136
    v_mfma_f32_32x32x16_bf16 v[160:175], a[8:11], v[144:147], v[160:175]
    v_exp_f32 v137, v137
    v_cvt_pk_bf16_f32 v155, v134, v135
    v_exp_f32 v138, v138
    v_exp_f32 v139, v139
    v_cvt_pk_bf16_f32 v156, v136, v137
    v_exp_f32 v140, v140
    v_mfma_f32_32x32x16_bf16 v[160:175], a[12:15], v[148:151], v[160:175]
    buffer_load_dwordx4 a[60:63], v2, s[44:47], s11 offen offset:3072 sc1
    v_exp_f32 v141, v141
    v_exp_f32 v142, v142
    v_cvt_pk_bf16_f32 v157, v138, v139
    v_exp_f32 v143, v143
    v_cvt_pk_bf16_f32 v158, v140, v141
    v_cvt_pk_bf16_f32 v159, v142, v143
    v_mfma_f32_32x32x16_bf16 v[128:143], a[0:3], v[40:43], 0
    buffer_load_dwordx4 a[64:67], v6, s[4:7], s13 offen offset:0 sc1
    v_exp_f32 v112, v112
    v_exp_f32 v113, v113
    v_exp_f32 v114, v114
    v_exp_f32 v115, v115
    v_cvt_pk_bf16_f32 v144, v112, v113
    v_exp_f32 v116, v116
    v_mfma_f32_32x32x16_bf16 v[128:143], a[4:7], v[44:47], v[128:143]
    v_exp_f32 v117, v117
    v_cvt_pk_bf16_f32 v145, v114, v115
    v_exp_f32 v118, v118
    v_exp_f32 v119, v119
    v_cvt_pk_bf16_f32 v146, v116, v117
    v_exp_f32 v120, v120
    v_mfma_f32_32x32x16_bf16 v[176:191], a[8:11], v[152:155], v[176:191]
    buffer_load_dwordx4 a[68:71], v7, s[4:7], s13 offen offset:0 sc1
    v_exp_f32 v121, v121
    v_cvt_pk_bf16_f32 v147, v118, v119
    v_exp_f32 v122, v122
    v_exp_f32 v123, v123
    v_cvt_pk_bf16_f32 v148, v120, v121
    v_exp_f32 v124, v124
    v_mfma_f32_32x32x16_bf16 v[176:191], a[12:15], v[156:159], v[176:191]
    s_waitcnt vmcnt(18)
    v_exp_f32 v125, v125
    v_exp_f32 v126, v126
    v_cvt_pk_bf16_f32 v149, v122, v123
    v_exp_f32 v127, v127
    v_cvt_pk_bf16_f32 v150, v124, v125
    v_cvt_pk_bf16_f32 v151, v126, v127
    v_mfma_f32_32x32x16_bf16 v[112:127], a[16:19], v[16:19], 0
    buffer_load_dwordx4 a[72:75], v6, s[4:7], s13 offen offset:2048 sc1
    v_exp_f32 v128, v128
    v_exp_f32 v129, v129
    v_exp_f32 v130, v130
    v_exp_f32 v131, v131
    v_cvt_pk_bf16_f32 v152, v128, v129
    v_exp_f32 v132, v132
    v_mfma_f32_32x32x16_bf16 v[112:127], a[20:23], v[20:23], v[112:127]
    v_exp_f32 v133, v133
    v_cvt_pk_bf16_f32 v153, v130, v131
    v_exp_f32 v134, v134
    v_exp_f32 v135, v135
    v_cvt_pk_bf16_f32 v154, v132, v133
    v_exp_f32 v136, v136
    v_mfma_f32_32x32x16_bf16 v[192:207], a[8:11], v[144:147], v[192:207]
    buffer_load_dwordx4 a[76:79], v7, s[4:7], s13 offen offset:2048 sc1
    s_cbranch_execz L_walk
    v_exp_f32 v137, v137
    v_cvt_pk_bf16_f32 v155, v134, v135
    v_exp_f32 v138, v138
    v_exp_f32 v139, v139
    v_cvt_pk_bf16_f32 v156, v136, v137
    v_exp_f32 v140, v140
    v_mfma_f32_32x32x16_bf16 v[192:207], a[12:15], v[148:151], v[192:207]
    v_exp_f32 v141, v141
    v_exp_f32 v142, v142
    v_cvt_pk_bf16_f32 v157, v138, v139
    v_exp_f32 v143, v143
    v_cvt_pk_bf16_f32 v158, v140, v141
    v_cvt_pk_bf16_f32 v159, v142, v143
    v_mfma_f32_32x32x16_bf16 v[128:143], a[16:19], v[24:27], 0
    s_add_u32 s13, s13, 4096
    v_exp_f32 v112, v112
    v_exp_f32 v113, v113
    v_exp_f32 v114, v114
    v_exp_f32 v115, v115
    v_cvt_pk_bf16_f32 v144, v112, v113
    v_exp_f32 v116, v116
    v_mfma_f32_32x32x16_bf16 v[128:143], a[20:23], v[28:31], v[128:143]
    buffer_load_dwordx4 a[80:83], v6, s[4:7], s13 offen offset:0 sc1
    v_exp_f32 v117, v117
    v_cvt_pk_bf16_f32 v145, v114, v115
    v_exp_f32 v118, v118
    v_exp_f32 v119, v119
    v_cvt_pk_bf16_f32 v146, v116, v117
    v_exp_f32 v120, v120
    v_mfma_f32_32x32x16_bf16 v[48:63], a[8:11], v[152:155], v[48:63]
    v_exp_f32 v121, v121
    v_cvt_pk_bf16_f32 v147, v118, v119
    v_exp_f32 v122, v122
    v_exp_f32 v123, v123
    v_cvt_pk_bf16_f32 v148, v120, v121
    v_exp_f32 v124, v124
    v_mfma_f32_32x32x16_bf16 v[48:63], a[12:15], v[156:159], v[48:63]
    buffer_load_dwordx4 a[84:87], v7, s[4:7], s13 offen offset:0 sc1
    v_exp_f32 v125, v125
    v_exp_f32 v126, v126
    v_cvt_pk_bf16_f32 v149, v122, v123
    v_exp_f32 v127, v127
    v_cvt_pk_bf16_f32 v150, v124, v125
    v_cvt_pk_bf16_f32 v151, v126, v127
    v_mfma_f32_32x32x16_bf16 v[112:127], a[16:19], v[32:35], 0
    v_exp_f32 v128, v128
    v_exp_f32 v129, v129
    v_exp_f32 v130, v130
    v_exp_f32 v131, v131
    v_cvt_pk_bf16_f32 v152, v128, v129
    v_exp_f32 v132, v132
    v_mfma_f32_32x32x16_bf16 v[112:127], a[20:23], v[36:39], v[112:127]
    buffer_load_dwordx4 a[88:91], v6, s[4:7], s13 offen offset:2048 sc1
    v_exp_f32 v133, v133
    v_cvt_pk_bf16_f32 v153, v130, v131
    v_exp_f32 v134, v134
    v_exp_f32 v135, v135
    v_cvt_pk_bf16_f32 v154, v132, v133
    v_exp_f32 v136, v136
    v_mfma_f32_32x32x16_bf16 v[160:175], a[24:27], v[144:147], v[160:175]
    v_exp_f32 v137, v137
    v_cvt_pk_bf16_f32 v155, v134, v135
    v_exp_f32 v138, v138
    v_exp_f32 v139, v139
    v_cvt_pk_bf16_f32 v156, v136, v137
    v_exp_f32 v140, v140
    v_mfma_f32_32x32x16_bf16 v[160:175], a[28:31], v[148:151], v[160:175]
    buffer_load_dwordx4 a[92:95], v7, s[4:7], s13 offen offset:2048 sc1
    v_exp_f32 v141, v141
    v_exp_f32 v142, v142
    v_cvt_pk_bf16_f32 v157, v138, v139
    v_exp_f32 v143, v143
    v_cvt_pk_bf16_f32 v158, v140, v141
    v_cvt_pk_bf16_f32 v159, v142, v143
    v_mfma_f32_32x32x16_bf16 v[128:143], a[16:19], v[40:43], 0
    v_exp_f32 v112, v112
    v_exp_f32 v113, v113
    v_exp_f32 v114, v114
    v_exp_f32 v115, v115
    v_cvt_pk_bf16_f32 v144, v112, v113
    v_exp_f32 v116, v116
    v_mfma_f32_32x32x16_bf16 v[128:143], a[20:23], v[44:47], v[128:143]
    s_add_u32 s13, s13, 4096
    v_exp_f32 v117, v117
    v_cvt_pk_bf16_f32 v145, v114, v115
    v_exp_f32 v118, v118
    v_exp_f32 v119, v119
    s_cbranch_execz L_walk
    v_cvt_pk_bf16_f32 v146, v116, v117
    v_exp_f32 v120, v120
    v_mfma_f32_32x32x16_bf16 v[176:191], a[24:27], v[152:155], v[176:191]
    buffer_load_dwordx4 a[96:99], v6, s[4:7], s13 offen offset:0 sc1
    v_exp_f32 v121, v121
    v_cvt_pk_bf16_f32 v147, v118, v119
    v_exp_f32 v122, v122
    v_exp_f32 v123, v123
    v_cvt_pk_bf16_f32 v148, v120, v121
    v_exp_f32 v124, v124
    v_mfma_f32_32x32x16_bf16 v[176:191], a[28:31], v[156:159], v[176:191]
    s_waitcnt vmcnt(17)
    v_exp_f32 v125, v125
    v_exp_f32 v126, v126
    v_cvt_pk_bf16_f32 v149, v122, v123
    v_exp_f32 v127, v127
    v_cvt_pk_bf16_f32 v150, v124, v125
    v_cvt_pk_bf16_f32 v151, v126, v127
    v_mfma_f32_32x32x16_bf16 v[112:127], a[32:35], v[16:19], 0
    buffer_load_dwordx4 a[100:103], v7, s[4:7], s13 offen offset:0 sc1
    v_exp_f32 v128, v128
    v_exp_f32 v129, v129
    v_exp_f32 v130, v130
    v_exp_f32 v131, v131
    v_cvt_pk_bf16_f32 v152, v128, v129
    v_exp_f32 v132, v132
    v_mfma_f32_32x32x16_bf16 v[112:127], a[36:39], v[20:23], v[112:127]
    v_exp_f32 v133, v133
    v_cvt_pk_bf16_f32 v153, v130, v131
    v_exp_f32 v134, v134
    v_exp_f32 v135, v135
    v_cvt_pk_bf16_f32 v154, v132, v133
    v_exp_f32 v136, v136
    v_mfma_f32_32x32x16_bf16 v[192:207], a[24:27], v[144:147], v[192:207]
    buffer_load_dwordx4 a[104:107], v6, s[4:7], s13 offen offset:2048 sc1
    v_exp_f32 v137, v137
    v_cvt_pk_bf16_f32 v155, v134, v135
    v_exp_f32 v138, v138
    v_exp_f32 v139, v139
    v_cvt_pk_bf16_f32 v156, v136, v137
    v_exp_f32 v140, v140
    v_mfma_f32_32x32x16_bf16 v[192:207], a[28:31], v[148:151], v[192:207]
    v_exp_f32 v141, v141
    v_exp_f32 v142, v142
    v_cvt_pk_bf16_f32 v157, v138, v139
    v_exp_f32 v143, v143
    v_cvt_pk_bf16_f32 v158, v140, v141
    v_cvt_pk_bf16_f32 v159, v142, v143
    v_mfma_f32_32x32x16_bf16 v[128:143], a[32:35], v[24:27], 0
    buffer_load_dwordx4 a[108:111], v7, s[4:7], s13 offen offset:2048 sc1
    v_exp_f32 v112, v112
    v_exp_f32 v113, v113
    v_exp_f32 v114, v114
    v_exp_f32 v115, v115
    v_cvt_pk_bf16_f32 v144, v112, v113
    v_exp_f32 v116, v116
    v_mfma_f32_32x32x16_bf16 v[128:143], a[36:39], v[28:31], v[128:143]
    v_exp_f32 v117, v117
    v_cvt_pk_bf16_f32 v145, v114, v115
    v_exp_f32 v118, v118
    v_exp_f32 v119, v119
    v_cvt_pk_bf16_f32 v146, v116, v117
    v_exp_f32 v120, v120
    v_mfma_f32_32x32x16_bf16 v[48:63], a[24:27], v[152:155], v[48:63]
    s_add_u32 s13, s13, 4096
    v_exp_f32 v121, v121
    v_cvt_pk_bf16_f32 v147, v118, v119
    v_exp_f32 v122, v122
    v_exp_f32 v123, v123
    v_cvt_pk_bf16_f32 v148, v120, v121
    v_exp_f32 v124, v124
    v_mfma_f32_32x32x16_bf16 v[48:63], a[28:31], v[156:159], v[48:63]
    buffer_load_dwordx4 a[112:115], v6, s[4:7], s13 offen offset:0 sc1
    v_exp_f32 v125, v125
    v_exp_f32 v126, v126
    v_cvt_pk_bf16_f32 v149, v122, v123
    v_exp_f32 v127, v127
    v_cvt_pk_bf16_f32 v150, v124, v125
    v_cvt_pk_bf16_f32 v151, v126, v127
    v_mfma_f32_32x32x16_bf16 v[112:127], a[32:35], v[32:35], 0
    v_exp_f32 v128, v128
    v_exp_f32 v129, v129
    v_exp_f32 v130, v130
    v_exp_f32 v131, v131
    v_cvt_pk_bf16_f32 v152, v128, v129
    v_exp_f32 v132, v132
    s_nop 0
    s_cbranch_execz L_walk
    v_mfma_f32_32x32x16_bf16 v[112:127], a[36:39], v[36:39], v[112:127]
    buffer_load_dwordx4 a[116:119], v7, s[4:7], s13 offen offset:0 sc1
    v_exp_f32 v133, v133
    v_cvt_pk_bf16_f32 v153, v130, v131
    v_exp_f32 v134, v134
    v_exp_f32 v135, v135
    v_cvt_pk_bf16_f32 v154, v132, v133
    v_exp_f32 v136, v136
    v_mfma_f32_32x32x16_bf16 v[160:175], a[40:43], v[144:147], v[160:175]
    v_exp_f32 v137, v137
    v_cvt_pk_bf16_f32 v155, v134, v135
    v_exp_f32 v138, v138
    v_exp_f32 v139, v139
    v_cvt_pk_bf16_f32 v156, v136, v137
    v_exp_f32 v140, v140
    v_mfma_f32_32x32x16_bf16 v[160:175], a[44:47], v[148:151], v[160:175]
    buffer_load_dwordx4 a[120:123], v6, s[4:7], s13 offen offset:2048 sc1
    v_exp_f32 v141, v141
    v_exp_f32 v142, v142
    v_cvt_pk_bf16_f32 v157, v138, v139
    v_exp_f32 v143, v143
    v_cvt_pk_bf16_f32 v158, v140, v141
    v_cvt_pk_bf16_f32 v159, v142, v143
    v_mfma_f32_32x32x16_bf16 v[128:143], a[32:35], v[40:43], 0
    v_exp_f32 v112, v112
    v_exp_f32 v113, v113
    v_exp_f32 v114, v114
    v_exp_f32 v115, v115
    v_cvt_pk_bf16_f32 v144, v112, v113
    v_exp_f32 v116, v116
    v_mfma_f32_32x32x16_bf16 v[128:143], a[36:39], v[44:47], v[128:143]
    buffer_load_dwordx4 a[124:127], v7, s[4:7], s13 offen offset:2048 sc1
    v_exp_f32 v117, v117
    v_cvt_pk_bf16_f32 v145, v114, v115
    v_exp_f32 v118, v118
    v_exp_f32 v119, v119
    v_cvt_pk_bf16_f32 v146, v116, v117
    v_exp_f32 v120, v120
    v_mfma_f32_32x32x16_bf16 v[176:191], a[40:43], v[152:155], v[176:191]
    v_exp_f32 v121, v121
    v_cvt_pk_bf16_f32 v147, v118, v119
    v_exp_f32 v122, v122
    v_exp_f32 v123, v123
    v_cvt_pk_bf16_f32 v148, v120, v121
    v_exp_f32 v124, v124
    v_mfma_f32_32x32x16_bf16 v[176:191], a[44:47], v[156:159], v[176:191]
    s_waitcnt vmcnt(16)
    v_exp_f32 v125, v125
    v_exp_f32 v126, v126
    v_cvt_pk_bf16_f32 v149, v122, v123
    v_exp_f32 v127, v127
    v_cvt_pk_bf16_f32 v150, v124, v125
    v_cvt_pk_bf16_f32 v151, v126, v127
    v_mfma_f32_32x32x16_bf16 v[112:127], a[48:51], v[16:19], 0
    buffer_load_dword v87, v210, s[4:7], 0 offen sc1
    v_exp_f32 v128, v128
    v_exp_f32 v129, v129
    v_exp_f32 v130, v130
    v_exp_f32 v131, v131
    v_cvt_pk_bf16_f32 v152, v128, v129
    v_exp_f32 v132, v132
    v_mfma_f32_32x32x16_bf16 v[112:127], a[52:55], v[20:23], v[112:127]
    v_exp_f32 v133, v133
    v_cvt_pk_bf16_f32 v153, v130, v131
    v_exp_f32 v134, v134
    v_exp_f32 v135, v135
    v_cvt_pk_bf16_f32 v154, v132, v133
    v_exp_f32 v136, v136
    v_mfma_f32_32x32x16_bf16 v[192:207], a[40:43], v[144:147], v[192:207]
    buffer_load_dwordx2 v[14:15], v84, s[4:7], s32 offen offset:2560 sc1
    v_exp_f32 v137, v137
    v_cvt_pk_bf16_f32 v155, v134, v135
    v_exp_f32 v138, v138
    v_exp_f32 v139, v139
    v_cvt_pk_bf16_f32 v156, v136, v137
    v_exp_f32 v140, v140
    v_mfma_f32_32x32x16_bf16 v[192:207], a[44:47], v[148:151], v[192:207]
    v_exp_f32 v141, v141
    v_exp_f32 v142, v142
    v_cvt_pk_bf16_f32 v157, v138, v139
    v_exp_f32 v143, v143
    v_cvt_pk_bf16_f32 v158, v140, v141
    v_cvt_pk_bf16_f32 v159, v142, v143
    v_mfma_f32_32x32x16_bf16 v[128:143], a[48:51], v[24:27], 0
    v_exp_f32 v112, v112
    v_exp_f32 v113, v113
    v_exp_f32 v114, v114
    s_cbranch_execz L_walk
    v_exp_f32 v115, v115
    v_cvt_pk_bf16_f32 v144, v112, v113
    v_exp_f32 v116, v116
    v_mfma_f32_32x32x16_bf16 v[128:143], a[52:55], v[28:31], v[128:143]
    v_exp_f32 v117, v117
    v_cvt_pk_bf16_f32 v145, v114, v115
    v_exp_f32 v118, v118
    v_exp_f32 v119, v119
    v_cvt_pk_bf16_f32 v146, v116, v117
    v_exp_f32 v120, v120
    v_mfma_f32_32x32x16_bf16 v[48:63], a[40:43], v[152:155], v[48:63]
    v_exp_f32 v121, v121
    v_cvt_pk_bf16_f32 v147, v118, v119
    v_exp_f32 v122, v122
    v_exp_f32 v123, v123
    v_cvt_pk_bf16_f32 v148, v120, v121
    v_exp_f32 v124, v124
    v_mfma_f32_32x32x16_bf16 v[48:63], a[44:47], v[156:159], v[48:63]
    v_exp_f32 v125, v125
    v_exp_f32 v126, v126
    v_cvt_pk_bf16_f32 v149, v122, v123
    v_exp_f32 v127, v127
    v_cvt_pk_bf16_f32 v150, v124, v125
    v_cvt_pk_bf16_f32 v151, v126, v127
    v_mfma_f32_32x32x16_bf16 v[160:175], a[56:59], v[144:147], v[160:175]
    v_exp_f32 v128, v128
    v_exp_f32 v129, v129
    v_exp_f32 v130, v130
    v_exp_f32 v131, v131
    v_cvt_pk_bf16_f32 v152, v128, v129
    v_exp_f32 v132, v132
    v_mfma_f32_32x32x16_bf16 v[160:175], a[60:63], v[148:151], v[160:175]
    v_exp_f32 v133, v133
    v_cvt_pk_bf16_f32 v153, v130, v131
    v_exp_f32 v134, v134
    v_exp_f32 v135, v135
    v_cvt_pk_bf16_f32 v154, v132, v133
    v_exp_f32 v136, v136
    v_mfma_f32_32x32x16_bf16 v[112:127], a[48:51], v[32:35], 0
    v_exp_f32 v137, v137
    v_cvt_pk_bf16_f32 v155, v134, v135
    v_exp_f32 v138, v138
    v_exp_f32 v139, v139
    v_cvt_pk_bf16_f32 v156, v136, v137
    v_exp_f32 v140, v140
    v_mfma_f32_32x32x16_bf16 v[112:127], a[52:55], v[36:39], v[112:127]
    v_exp_f32 v141, v141
    v_exp_f32 v142, v142
    v_cvt_pk_bf16_f32 v157, v138, v139
    v_exp_f32 v143, v143
    v_cvt_pk_bf16_f32 v158, v140, v141
    v_cvt_pk_bf16_f32 v159, v142, v143
    s_nop 3
    v_mfma_f32_32x32x16_bf16 v[176:191], a[56:59], v[152:155], v[176:191]
    ds_write_b128 v11, v[160:163] offset:0
    v_exp_f32 v112, v112
    v_exp_f32 v113, v113
    v_exp_f32 v114, v114
    v_exp_f32 v115, v115
    v_cvt_pk_bf16_f32 v144, v112, v113
    v_exp_f32 v116, v116
    v_mfma_f32_32x32x16_bf16 v[176:191], a[60:63], v[156:159], v[176:191]
    ds_write_b128 v11, v[164:167] offset:1024
    v_exp_f32 v117, v117
    v_cvt_pk_bf16_f32 v145, v114, v115
    v_exp_f32 v118, v118
    v_exp_f32 v119, v119
    v_cvt_pk_bf16_f32 v146, v116, v117
    v_exp_f32 v120, v120
    v_mfma_f32_32x32x16_bf16 v[128:143], a[48:51], v[40:43], 0
    ds_write_b128 v11, v[168:171] offset:2048
    v_exp_f32 v121, v121
    v_cvt_pk_bf16_f32 v147, v118, v119
    v_exp_f32 v122, v122
    v_exp_f32 v123, v123
    v_cvt_pk_bf16_f32 v148, v120, v121
    v_exp_f32 v124, v124
    v_mfma_f32_32x32x16_bf16 v[128:143], a[52:55], v[44:47], v[128:143]
    ds_write_b128 v11, v[172:175] offset:3072
    v_exp_f32 v125, v125
    v_exp_f32 v126, v126
    v_cvt_pk_bf16_f32 v149, v122, v123
    v_exp_f32 v127, v127
    v_cvt_pk_bf16_f32 v150, v124, v125
    v_cvt_pk_bf16_f32 v151, v126, v127
    s_nop 2
    v_mfma_f32_32x32x16_bf16 v[192:207], a[56:59], v[144:147], v[192:207]
    s_cbranch_execz L_walk
    ds_write_b128 v10, v[176:179] offset:0
    v_exp_f32 v128, v128
    v_exp_f32 v129, v129
    v_exp_f32 v130, v130
    v_exp_f32 v131, v131
    v_cvt_pk_bf16_f32 v152, v128, v129
    v_exp_f32 v132, v132
    v_mfma_f32_32x32x16_bf16 v[192:207], a[60:63], v[148:151], v[192:207]
    ds_write_b128 v10, v[180:183] offset:1024
    v_exp_f32 v133, v133
    v_cvt_pk_bf16_f32 v153, v130, v131
    v_exp_f32 v134, v134
    v_exp_f32 v135, v135
    v_cvt_pk_bf16_f32 v154, v132, v133
    v_exp_f32 v136, v136
    ds_write_b128 v10, v[184:187] offset:2048
    v_exp_f32 v137, v137
    v_cvt_pk_bf16_f32 v155, v134, v135
    v_exp_f32 v138, v138
    v_exp_f32 v139, v139
    v_cvt_pk_bf16_f32 v156, v136, v137
    v_exp_f32 v140, v140
    ds_write_b128 v10, v[188:191] offset:3072
    v_exp_f32 v141, v141
    v_exp_f32 v142, v142
    v_cvt_pk_bf16_f32 v157, v138, v139
    v_exp_f32 v143, v143
    v_cvt_pk_bf16_f32 v158, v140, v141
    v_cvt_pk_bf16_f32 v159, v142, v143
    ds_write_b128 v9, v[192:195] offset:0
    ds_write_b128 v9, v[196:199] offset:1024
    v_mfma_f32_32x32x16_bf16 v[48:63], a[56:59], v[152:155], v[48:63]
    v_mfma_f32_32x32x16_bf16 v[48:63], a[60:63], v[156:159], v[48:63]
    ds_write_b128 v9, v[200:203] offset:2048
    ds_write_b128 v9, v[204:207] offset:3072
L_tailr:
    s_getreg_b32 s25, hwreg(HW_REG_XCC_ID, 0, 4)
    s_or_b32 s24, s25, s42
    s_mov_b32 s25, s43
    s_waitcnt vmcnt(0) lgkmcnt(0)
    s_barrier
    ds_read_b128 v[160:163], v8 offset:0
    ds_read_b128 v[164:167], v8 offset:1024
    ds_read_b128 v[168:171], v8 offset:2048
    ds_read_b128 v[172:175], v8 offset:3072
    ds_read_b128 v[176:179], v8 offset:4096
    ds_read_b128 v[180:183], v8 offset:5120
    ds_read_b128 v[184:187], v8 offset:6144
    ds_read_b128 v[188:191], v8 offset:7168
    ds_read_b128 v[192:195], v8 offset:8192
    ds_read_b128 v[196:199], v8 offset:9216
    ds_read_b128 v[200:203], v8 offset:10240
    ds_read_b128 v[204:207], v8 offset:11264
    v_cmp_ne_u64 vcc, s[24:25], v[14:15]
    s_mov_b32 s14, 0x2b800000
    s_mov_b32 s16, 0x53800000
    s_cmp_lg_u64 vcc, 0
    s_cselect_b32 s35, 1, 0
    s_or_b32 s29, s30, s35
    s_xor_b32 s79, s30, 1
    s_and_b32 s79, s79, 1
    s_or_b32 s79, s79, s35
    s_waitcnt lgkmcnt(8)
    v_pk_add_f32 v[48:49], v[48:49], v[160:161]
    v_pk_add_f32 v[50:51], v[50:51], v[162:163]
    v_pk_add_f32 v[52:53], v[52:53], v[164:165]
    v_pk_add_f32 v[54:55], v[54:55], v[166:167]
    v_pk_add_f32 v[56:57], v[56:57], v[168:169]
    v_pk_add_f32 v[58:59], v[58:59], v[170:171]
    v_pk_add_f32 v[60:61], v[60:61], v[172:173]
    v_pk_add_f32 v[62:63], v[62:63], v[174:175]
    s_waitcnt lgkmcnt(4)
    v_pk_add_f32 v[48:49], v[48:49], v[176:177]
    v_pk_add_f32 v[50:51], v[50:51], v[178:179]
    v_pk_add_f32 v[52:53], v[52:53], v[180:181]
    v_pk_add_f32 v[54:55], v[54:55], v[182:183]
    v_pk_add_f32 v[56:57], v[56:57], v[184:185]
    v_pk_add_f32 v[58:59], v[58:59], v[186:187]
    v_pk_add_f32 v[60:61], v[60:61], v[188:189]
    s_nop 0
    s_cbranch_execz L_walk
    v_pk_add_f32 v[62:63], v[62:63], v[190:191]
    s_waitcnt lgkmcnt(0)
    v_pk_add_f32 v[48:49], v[48:49], v[192:193]
    v_pk_add_f32 v[50:51], v[50:51], v[194:195]
    v_pk_add_f32 v[52:53], v[52:53], v[196:197]
    v_pk_add_f32 v[54:55], v[54:55], v[198:199]
    v_pk_add_f32 v[56:57], v[56:57], v[200:201]
    v_pk_add_f32 v[58:59], v[58:59], v[202:203]
    v_pk_add_f32 v[60:61], v[60:61], v[204:205]
    v_pk_add_f32 v[62:63], v[62:63], v[206:207]
    v_mov_b32 v12, v60
    v_mov_b32 v13, v60
    s_mov_b32 s11, s69
    s_mov_b32 s12, s70
    v_permlane32_swap_b32 v12, v13
    v_cmp_lt_f32 vcc, s14, v13
    v_cmp_gt_f32 s[24:25], s16, v13
    s_and_b64 vcc, vcc, s[24:25]
    s_cmp_eq_u64 vcc, exec
    s_cbranch_scc0 L_slow
L_fin:
    v_rcp_f32 v12, v13
    s_nop 0
    v_pk_mul_f32 v[48:49], v[48:49], v[12:13] op_sel_hi:[1,0]
    v_pk_mul_f32 v[50:51], v[50:51], v[12:13] op_sel_hi:[1,0]
    v_pk_mul_f32 v[52:53], v[52:53], v[12:13] op_sel_hi:[1,0]
    v_pk_mul_f32 v[54:55], v[54:55], v[12:13] op_sel_hi:[1,0]
    v_pk_mul_f32 v[56:57], v[56:57], v[12:13] op_sel_hi:[1,0]
    v_pk_mul_f32 v[58:59], v[58:59], v[12:13] op_sel_hi:[1,0]
    v_pk_mul_f32 v[60:61], v[60:61], v[12:13] op_sel_hi:[1,0]
    v_pk_mul_f32 v[62:63], v[62:63], v[12:13] op_sel_hi:[1,0]
    v_cvt_pk_bf16_f32 v144, v48, v49
    v_cvt_pk_bf16_f32 v145, v50, v51
    v_cvt_pk_bf16_f32 v146, v52, v53
    v_cvt_pk_bf16_f32 v147, v54, v55
    v_cvt_pk_bf16_f32 v148, v56, v57
    v_cvt_pk_bf16_f32 v149, v58, v59
    v_cvt_pk_bf16_f32 v150, v60, v61
    v_cvt_pk_bf16_f32 v151, v62, v63
    s_cmp_lg_u32 s79, 0
    s_cbranch_scc1 L_hs3
    buffer_store_dwordx4 v[144:147], v2, s[4:7], s65 offen
    buffer_store_dwordx4 v[148:151], v2, s[4:7], s65 offen offset:1024
L_hb3:
    s_cmp_eq_u32 s30, 0
    s_cbranch_scc1 L_cs1
L_cs1b:
    s_waitcnt vmcnt(0)
    s_add_u32 s24, s1, s76
    s_mov_b64 exec, 1
    s_cmp_lg_u32 s35, 0
    s_cbranch_scc1 L_hs4
    buffer_store_dwordx2 v[214:215], off, s[4:7], s24 offset:0
L_hb4:
    s_mov_b64 exec, -1
    s_cmp_ge_u32 s9, 14
    s_cbranch_scc1 L_idle
    s_cmp_eq_u32 s30, 0
    s_cbranch_scc1 L_cs2
L_cs2b:
    buffer_load_dwordx2 v[14:15], v3, s[4:7], s32 offen offset:0 sc1
    s_waitcnt vmcnt(0)
    v_cmp_ne_u64 vcc, s[42:43], v[14:15]
    s_cbranch_vccnz L_pl5
L_pb5:
    buffer_load_dwordx4 a[0:3], v2, s[4:7], s11 offen offset:0 sc1
    buffer_load_dwordx4 a[4:7], v2, s[4:7], s12 offen offset:0 sc1
    buffer_load_dwordx4 a[8:11], v2, s[4:7], s11 offen offset:1024 sc1
    buffer_load_dwordx4 a[12:15], v2, s[4:7], s12 offen offset:1024 sc1
    buffer_load_dwordx4 a[16:19], v2, s[4:7], s11 offen offset:2048 sc1
    buffer_load_dwordx4 a[20:23], v2, s[4:7], s12 offen offset:2048 sc1
    buffer_load_dwordx4 a[24:27], v2, s[4:7], s11 offen offset:3072 sc1
    buffer_load_dwordx4 a[28:31], v2, s[4:7], s12 offen offset:3072 sc1
    s_waitcnt vmcnt(6)
    v_mfma_f32_32x32x16_bf16 v[16:31], a[64:67], a[0:3], v[240:255]
    s_add_u32 s11, s11, 4096
    s_add_u32 s12, s12, 4096
    buffer_load_dwordx4 a[32:35], v2, s[4:7], s11 offen offset:0 sc1
    v_mfma_f32_32x32x16_bf16 v[32:47], a[64:67], a[4:7], 0
    buffer_load_dwordx4 a[36:39], v2, s[4:7], s12 offen offset:0 sc1
    v_mfma_f32_32x32x16_bf16 v[48:63], a[68:71], a[0:3], 0
    buffer_load_dwordx4 a[40:43], v2, s[4:7], s11 offen offset:1024 sc1
    v_mfma_f32_32x32x16_bf16 v[64:79], a[68:71], a[4:7], 0
    s_waitcnt vmcnt(7)
    v_mfma_f32_32x32x16_bf16 v[16:31], a[72:75], a[8:11], v[16:31]
    s_cbranch_execz L_walk
    buffer_load_dwordx4 a[44:47], v2, s[4:7], s12 offen offset:1024 sc1
    v_mfma_f32_32x32x16_bf16 v[32:47], a[72:75], a[12:15], v[32:47]
    buffer_load_dwordx4 a[48:51], v2, s[4:7], s11 offen offset:2048 sc1
    v_mfma_f32_32x32x16_bf16 v[48:63], a[76:79], a[8:11], v[48:63]
    buffer_load_dwordx4 a[52:55], v2, s[4:7], s12 offen offset:2048 sc1
    v_mfma_f32_32x32x16_bf16 v[64:79], a[76:79], a[12:15], v[64:79]
    s_waitcnt vmcnt(8)
    v_mfma_f32_32x32x16_bf16 v[16:31], a[80:83], a[16:19], v[16:31]
    buffer_load_dwordx4 a[56:59], v2, s[4:7], s11 offen offset:3072 sc1
    v_mfma_f32_32x32x16_bf16 v[32:47], a[80:83], a[20:23], v[32:47]
    buffer_load_dwordx4 a[60:63], v2, s[4:7], s12 offen offset:3072 sc1
    v_mfma_f32_32x32x16_bf16 v[48:63], a[84:87], a[16:19], v[48:63]
    v_mfma_f32_32x32x16_bf16 v[64:79], a[84:87], a[20:23], v[64:79]
    s_waitcnt vmcnt(8)
    v_mfma_f32_32x32x16_bf16 v[16:31], a[88:91], a[24:27], v[16:31]
    v_mfma_f32_32x32x16_bf16 v[32:47], a[88:91], a[28:31], v[32:47]
    v_mfma_f32_32x32x16_bf16 v[48:63], a[92:95], a[24:27], v[48:63]
    v_mfma_f32_32x32x16_bf16 v[64:79], a[92:95], a[28:31], v[64:79]
    s_barrier
    s_waitcnt vmcnt(6)
    v_mfma_f32_32x32x16_bf16 v[32:47], a[96:99], a[36:39], v[32:47]
    s_waitcnt vmcnt(4)
    v_mfma_f32_32x32x16_bf16 v[32:47], a[104:107], a[44:47], v[32:47]
    s_waitcnt vmcnt(2)
    v_mfma_f32_32x32x16_bf16 v[32:47], a[112:115], a[52:55], v[32:47]
    s_waitcnt vmcnt(0)
    v_mfma_f32_32x32x16_bf16 v[32:47], a[120:123], a[60:63], v[32:47]
    s_nop 4
    v_mfma_f32_32x32x16_bf16 v[48:63], a[100:103], a[32:35], v[48:63]
    s_mul_i32 s27, s3, 14336
    s_sub_u32 s27, s74, s27
    s_add_u32 s27, s27, 114688
    buffer_load_dwordx4 v[96:99], v6, s[4:7], s27 offen offset:0 sc1
    s_nop 4
    v_mfma_f32_32x32x16_bf16 v[48:63], a[108:111], a[40:43], v[48:63]
    buffer_load_dwordx4 v[100:103], v7, s[4:7], s27 offen offset:0 sc1
    s_nop 4
    v_mfma_f32_32x32x16_bf16 v[48:63], a[116:119], a[48:51], v[48:63]
    buffer_load_dwordx4 v[104:107], v6, s[4:7], s27 offen offset:2048 sc1
    ds_write_b128 v9, v[32:35] offset:0
    ds_write_b128 v9, v[36:39] offset:1024
    s_nop 2
    v_mfma_f32_32x32x16_bf16 v[48:63], a[124:127], a[56:59], v[48:63]
    buffer_load_dwordx4 v[108:111], v7, s[4:7], s27 offen offset:2048 sc1
    ds_write_b128 v9, v[40:43] offset:2048
    ds_write_b128 v9, v[44:47] offset:3072
    s_nop 2
    v_mfma_f32_32x32x16_bf16 v[64:79], a[100:103], a[36:39], v[64:79]
    s_add_u32 s27, s27, 4096
    buffer_load_dwordx4 v[112:115], v6, s[4:7], s27 offen offset:0 sc1
    s_nop 4
    v_mfma_f32_32x32x16_bf16 v[64:79], a[108:111], a[44:47], v[64:79]
    buffer_load_dwordx4 v[116:119], v7, s[4:7], s27 offen offset:0 sc1
    s_nop 4
    v_mfma_f32_32x32x16_bf16 v[64:79], a[116:119], a[52:55], v[64:79]
    buffer_load_dwordx4 v[120:123], v6, s[4:7], s27 offen offset:2048 sc1
    ds_write_b128 v10, v[48:51] offset:0
    ds_write_b128 v10, v[52:55] offset:1024
    s_nop 2
    v_mfma_f32_32x32x16_bf16 v[64:79], a[124:127], a[60:63], v[64:79]
    buffer_load_dwordx4 v[124:127], v7, s[4:7], s27 offen offset:2048 sc1
    ds_write_b128 v10, v[56:59] offset:2048
    ds_write_b128 v10, v[60:63] offset:3072
    s_nop 2
    v_mfma_f32_32x32x16_bf16 v[16:31], a[96:99], a[32:35], v[16:31]
    s_add_u32 s27, s27, 4096
    buffer_load_dwordx4 v[128:131], v6, s[4:7], s27 offen offset:0 sc1
    s_nop 4
    v_mfma_f32_32x32x16_bf16 v[16:31], a[104:107], a[40:43], v[16:31]
    buffer_load_dwordx4 v[132:135], v7, s[4:7], s27 offen offset:0 sc1
    s_nop 4
    v_mfma_f32_32x32x16_bf16 v[16:31], a[112:115], a[48:51], v[16:31]
    buffer_load_dwordx4 v[136:139], v6, s[4:7], s27 offen offset:2048 sc1
    s_cbranch_execz L_walk
    ds_write_b128 v11, v[64:67] offset:0
    ds_write_b128 v11, v[68:71] offset:1024
    s_nop 2
    v_mfma_f32_32x32x16_bf16 v[16:31], a[120:123], a[56:59], v[16:31]
    buffer_load_dwordx4 v[140:143], v7, s[4:7], s27 offen offset:2048 sc1
    ds_write_b128 v11, v[72:75] offset:2048
    ds_write_b128 v11, v[76:79] offset:3072
    s_nop 2
    s_add_u32 s14, s66, 3145728
    s_add_u32 s19, s67, 6815744
    s_add_u32 s27, s27, 4096
    buffer_load_dwordx4 v[144:147], v6, s[4:7], s27 offen offset:0 sc1
    s_waitcnt lgkmcnt(0)
    s_barrier
    ds_read_b128 v[32:35], v8 offset:0
    ds_read_b128 v[36:39], v8 offset:1024
    ds_read_b128 v[40:43], v8 offset:2048
    ds_read_b128 v[44:47], v8 offset:3072
    ds_read_b128 v[48:51], v8 offset:4096
    ds_read_b128 v[52:55], v8 offset:5120
    ds_read_b128 v[56:59], v8 offset:6144
    ds_read_b128 v[60:63], v8 offset:7168
    ds_read_b128 v[64:67], v8 offset:8192
    ds_read_b128 v[68:71], v8 offset:9216
    ds_read_b128 v[72:75], v8 offset:10240
    ds_read_b128 v[76:79], v8 offset:11264
    buffer_load_dwordx4 v[148:151], v7, s[4:7], s27 offen offset:0 sc1
    s_add_u32 s27, s27, 45056
    buffer_load_dwordx4 v[152:155], v6, s[4:7], s27 offen offset:0 sc1
    s_waitcnt lgkmcnt(8)
    v_pk_add_f32 v[240:241], v[16:17], v[32:33]
    v_pk_add_f32 v[242:243], v[18:19], v[34:35]
    v_pk_add_f32 v[244:245], v[20:21], v[36:37]
    v_pk_add_f32 v[246:247], v[22:23], v[38:39]
    v_pk_add_f32 v[248:249], v[24:25], v[40:41]
    v_pk_add_f32 v[250:251], v[26:27], v[42:43]
    v_pk_add_f32 v[252:253], v[28:29], v[44:45]
    v_pk_add_f32 v[254:255], v[30:31], v[46:47]
    buffer_load_dwordx4 v[156:159], v7, s[4:7], s27 offen offset:0 sc1
    s_waitcnt lgkmcnt(4)
    v_pk_add_f32 v[240:241], v[240:241], v[48:49]
    v_pk_add_f32 v[242:243], v[242:243], v[50:51]
    v_pk_add_f32 v[244:245], v[244:245], v[52:53]
    v_pk_add_f32 v[246:247], v[246:247], v[54:55]
    v_pk_add_f32 v[248:249], v[248:249], v[56:57]
    v_pk_add_f32 v[250:251], v[250:251], v[58:59]
    v_pk_add_f32 v[252:253], v[252:253], v[60:61]
    v_pk_add_f32 v[254:255], v[254:255], v[62:63]
    buffer_load_dwordx4 v[160:163], v6, s[4:7], s27 offen offset:2048 sc1
    s_waitcnt lgkmcnt(0)
    v_pk_add_f32 v[240:241], v[240:241], v[64:65]
    v_pk_add_f32 v[242:243], v[242:243], v[66:67]
    v_pk_add_f32 v[244:245], v[244:245], v[68:69]
    v_pk_add_f32 v[246:247], v[246:247], v[70:71]
    v_pk_add_f32 v[248:249], v[248:249], v[72:73]
    v_pk_add_f32 v[250:251], v[250:251], v[74:75]
    v_pk_add_f32 v[252:253], v[252:253], v[76:77]
    v_pk_add_f32 v[254:255], v[254:255], v[78:79]
    v_cvt_pk_bf16_f32 v80, v240, v241
    v_cvt_pk_bf16_f32 v81, v242, v243
    v_cvt_pk_bf16_f32 v82, v244, v245
    v_cvt_pk_bf16_f32 v83, v246, v247
    v_cvt_pk_bf16_f32 v84, v248, v249
    v_cvt_pk_bf16_f32 v85, v250, v251
    v_cvt_pk_bf16_f32 v86, v252, v253
    v_cvt_pk_bf16_f32 v87, v254, v255
    s_cmp_lg_u32 s79, 0
    s_cbranch_scc1 L_hs6
    s_cbranch_execz L_walk
    buffer_store_dwordx4 v[80:83], v2, s[4:7], s14 offen
    buffer_store_dwordx4 v[84:87], v2, s[4:7], s14 offen offset:1024
L_hb6:
    v_pk_add_f32 v[88:89], v[240:241], v[242:243]
    v_pk_mul_f32 v[90:91], v[240:241], v[240:241]
    v_pk_fma_f32 v[90:91], v[242:243], v[242:243], v[90:91]
    v_pk_add_f32 v[88:89], v[88:89], v[244:245]
    v_pk_fma_f32 v[90:91], v[244:245], v[244:245], v[90:91]
    v_pk_add_f32 v[88:89], v[88:89], v[246:247]
    v_pk_fma_f32 v[90:91], v[246:247], v[246:247], v[90:91]
    v_pk_add_f32 v[88:89], v[88:89], v[248:249]
    v_pk_fma_f32 v[90:91], v[248:249], v[248:249], v[90:91]
    v_pk_add_f32 v[88:89], v[88:89], v[250:251]
    v_pk_fma_f32 v[90:91], v[250:251], v[250:251], v[90:91]
    v_pk_add_f32 v[88:89], v[88:89], v[252:253]
    v_pk_fma_f32 v[90:91], v[252:253], v[252:253], v[90:91]
    v_pk_add_f32 v[88:89], v[88:89], v[254:255]
    v_pk_fma_f32 v[90:91], v[254:255], v[254:255], v[90:91]
    v_add_f32 v88, v88, v89
    v_add_f32 v90, v90, v91
    s_nop 1
    v_permlane32_swap_b32 v88, v90
    v_add_f32 v88, v88, v90
    s_cmp_lg_u32 s79, 0
    s_cbranch_scc1 L_hs7
    buffer_store_dword v88, v4, s[4:7], s19 offen
L_hb7:
    s_mul_i32 s11, s10, 28672
    s_add_u32 s11, s11, 3145728
    s_lshl_b32 s14, s10, 12
    s_add_u32 s14, s14, 6815744
    v_mov_b32 v208, v213
    ds_read_b64_tr_b16 a[112:113], v208 offset:0
    ds_read_b64_tr_b16 a[114:115], v208 offset:1024
    ds_read_b64_tr_b16 a[116:117], v208 offset:512
    ds_read_b64_tr_b16 a[118:119], v208 offset:1536
    ds_read_b64_tr_b16 a[120:121], v208 offset:2048
    ds_read_b64_tr_b16 a[122:123], v208 offset:3072
    ds_read_b64_tr_b16 a[124:125], v208 offset:2560
    ds_read_b64_tr_b16 a[126:127], v208 offset:3584
    ds_read_b64_tr_b16 a[128:129], v208 offset:4096
    ds_read_b64_tr_b16 a[130:131], v208 offset:5120
    s_waitcnt vmcnt(0)
    s_add_u32 s24, s32, s18
    s_mov_b64 exec, 1
    s_cmp_lg_u32 s35, 0
    s_cbranch_scc1 L_hs8
    buffer_store_dwordx2 v[214:215], off, s[4:7], s24 offset:512
L_hb8:
    s_mov_b64 exec, -1
    buffer_load_dwordx2 v[14:15], v0, s[4:7], s32 offen offset:512 sc1
    s_waitcnt vmcnt(0)
    v_cmp_ne_u64 vcc, s[42:43], v[14:15]
    s_cbranch_vccnz L_pl9
L_pb9:
    buffer_load_dwordx4 a[0:3], v2, s[4:7], s11 offen offset:0 sc1
    buffer_load_dwordx4 a[4:7], v2, s[4:7], s11 offen offset:1024 sc1
    buffer_load_dwordx4 a[8:11], v2, s[4:7], s11 offen offset:2048 sc1
    buffer_load_dwordx4 a[12:15], v2, s[4:7], s11 offen offset:3072 sc1
    s_add_u32 s11, s11, 4096
    buffer_load_dwordx4 a[16:19], v2, s[4:7], s11 offen offset:0 sc1
    buffer_load_dwordx4 a[20:23], v2, s[4:7], s11 offen offset:1024 sc1
    buffer_load_dwordx4 a[24:27], v2, s[4:7], s11 offen offset:2048 sc1
    buffer_load_dwordx4 a[28:31], v2, s[4:7], s11 offen offset:3072 sc1
    ds_read_b64_tr_b16 a[132:133], v208 offset:4608
    ds_read_b64_tr_b16 a[134:135], v208 offset:5632
    s_waitcnt vmcnt(7) lgkmcnt(8)
    v_mfma_f32_32x32x16_bf16 v[16:31], a[112:115], a[0:3], 0
    s_add_u32 s11, s11, 4096
    buffer_load_dwordx4 a[32:35], v2, s[4:7], s11 offen offset:0 sc1
    ds_read_b64_tr_b16 a[136:137], v208 offset:6144
    ds_read_b64_tr_b16 a[138:139], v208 offset:7168
    v_mfma_f32_32x32x16_bf16 v[32:47], a[116:119], a[0:3], 0
    buffer_load_dword v80, v4, s[4:7], s14 offen offset:0 sc1
    ds_read_b64_tr_b16 a[140:141], v208 offset:6656
    ds_read_b64_tr_b16 a[142:143], v208 offset:7680
    s_waitcnt vmcnt(8) lgkmcnt(8)
    s_nop 0
    s_cbranch_execz L_walk
    v_mfma_f32_32x32x16_bf16 v[16:31], a[120:123], a[4:7], v[16:31]
    buffer_load_dwordx4 a[36:39], v2, s[4:7], s11 offen offset:1024 sc1
    ds_read_b64_tr_b16 a[112:113], v208 offset:8192
    ds_read_b64_tr_b16 a[114:115], v208 offset:9216
    v_mfma_f32_32x32x16_bf16 v[32:47], a[124:127], a[4:7], v[32:47]
    buffer_load_dword v81, v4, s[4:7], s14 offen offset:256 sc1
    ds_read_b64_tr_b16 a[116:117], v208 offset:8704
    ds_read_b64_tr_b16 a[118:119], v208 offset:9728
    s_waitcnt vmcnt(9) lgkmcnt(8)
    v_mfma_f32_32x32x16_bf16 v[16:31], a[128:131], a[8:11], v[16:31]
    buffer_load_dwordx4 a[40:43], v2, s[4:7], s11 offen offset:2048 sc1
    ds_read_b64_tr_b16 a[120:121], v208 offset:10240
    ds_read_b64_tr_b16 a[122:123], v208 offset:11264
    v_mfma_f32_32x32x16_bf16 v[32:47], a[132:135], a[8:11], v[32:47]
    buffer_load_dword v82, v4, s[4:7], s14 offen offset:512 sc1
    ds_read_b64_tr_b16 a[124:125], v208 offset:10752
    ds_read_b64_tr_b16 a[126:127], v208 offset:11776
    s_waitcnt vmcnt(10) lgkmcnt(8)
    v_mfma_f32_32x32x16_bf16 v[16:31], a[136:139], a[12:15], v[16:31]
    buffer_load_dwordx4 a[44:47], v2, s[4:7], s11 offen offset:3072 sc1
    ds_read_b64_tr_b16 a[128:129], v208 offset:12288
    ds_read_b64_tr_b16 a[130:131], v208 offset:13312
    v_mfma_f32_32x32x16_bf16 v[32:47], a[140:143], a[12:15], v[32:47]
    buffer_load_dword v83, v4, s[4:7], s14 offen offset:768 sc1
    ds_read_b64_tr_b16 a[132:133], v208 offset:12800
    ds_read_b64_tr_b16 a[134:135], v208 offset:13824
    s_waitcnt vmcnt(11) lgkmcnt(8)
    v_mfma_f32_32x32x16_bf16 v[16:31], a[112:115], a[16:19], v[16:31]
    s_add_u32 s11, s11, 4096
    buffer_load_dwordx4 a[48:51], v2, s[4:7], s11 offen offset:0 sc1
    ds_read_b64_tr_b16 a[136:137], v208 offset:14336
    ds_read_b64_tr_b16 a[138:139], v208 offset:15360
    v_mfma_f32_32x32x16_bf16 v[32:47], a[116:119], a[16:19], v[32:47]
    buffer_load_dword v84, v4, s[4:7], s14 offen offset:1024 sc1
    ds_read_b64_tr_b16 a[140:141], v208 offset:14848
    ds_read_b64_tr_b16 a[142:143], v208 offset:15872
    s_waitcnt vmcnt(12) lgkmcnt(8)
    v_mfma_f32_32x32x16_bf16 v[16:31], a[120:123], a[20:23], v[16:31]
    buffer_load_dwordx4 a[52:55], v2, s[4:7], s11 offen offset:1024 sc1
    ds_read_b64_tr_b16 a[112:113], v208 offset:16384
    ds_read_b64_tr_b16 a[114:115], v208 offset:17408
    v_mfma_f32_32x32x16_bf16 v[32:47], a[124:127], a[20:23], v[32:47]
    buffer_load_dword v85, v4, s[4:7], s14 offen offset:1280 sc1
    ds_read_b64_tr_b16 a[116:117], v208 offset:16896
    ds_read_b64_tr_b16 a[118:119], v208 offset:17920
    s_waitcnt vmcnt(13) lgkmcnt(8)
    v_mfma_f32_32x32x16_bf16 v[16:31], a[128:131], a[24:27], v[16:31]
    buffer_load_dwordx4 a[56:59], v2, s[4:7], s11 offen offset:2048 sc1
    ds_read_b64_tr_b16 a[120:121], v208 offset:18432
    ds_read_b64_tr_b16 a[122:123], v208 offset:19456
    v_mfma_f32_32x32x16_bf16 v[32:47], a[132:135], a[24:27], v[32:47]
    buffer_load_dword v86, v4, s[4:7], s14 offen offset:1536 sc1
    ds_read_b64_tr_b16 a[124:125], v208 offset:18944
    ds_read_b64_tr_b16 a[126:127], v208 offset:19968
    s_waitcnt vmcnt(14) lgkmcnt(8)
    v_mfma_f32_32x32x16_bf16 v[16:31], a[136:139], a[28:31], v[16:31]
    buffer_load_dwordx4 a[60:63], v2, s[4:7], s11 offen offset:3072 sc1
    ds_read_b64_tr_b16 a[128:129], v208 offset:20480
    ds_read_b64_tr_b16 a[130:131], v208 offset:21504
    v_mfma_f32_32x32x16_bf16 v[32:47], a[140:143], a[28:31], v[32:47]
    buffer_load_dword v87, v4, s[4:7], s14 offen offset:1792 sc1
    ds_read_b64_tr_b16 a[132:133], v208 offset:20992
    ds_read_b64_tr_b16 a[134:135], v208 offset:22016
    s_waitcnt vmcnt(15) lgkmcnt(8)
    v_mfma_f32_32x32x16_bf16 v[16:31], a[112:115], a[32:35], v[16:31]
    s_add_u32 s11, s11, 4096
    buffer_load_dwordx4 a[64:67], v2, s[4:7], s11 offen offset:0 sc1
    s_cbranch_execz L_walk
    ds_read_b64_tr_b16 a[136:137], v208 offset:22528
    ds_read_b64_tr_b16 a[138:139], v208 offset:23552
    v_mfma_f32_32x32x16_bf16 v[32:47], a[116:119], a[32:35], v[32:47]
    buffer_load_dword v88, v4, s[4:7], s14 offen offset:2048 sc1
    ds_read_b64_tr_b16 a[140:141], v208 offset:23040
    ds_read_b64_tr_b16 a[142:143], v208 offset:24064
    s_waitcnt vmcnt(15) lgkmcnt(8)
    v_mfma_f32_32x32x16_bf16 v[16:31], a[120:123], a[36:39], v[16:31]
    buffer_load_dwordx4 a[68:71], v2, s[4:7], s11 offen offset:1024 sc1
    ds_read_b64_tr_b16 a[112:113], v208 offset:24576
    ds_read_b64_tr_b16 a[114:115], v208 offset:25600
    v_mfma_f32_32x32x16_bf16 v[32:47], a[124:127], a[36:39], v[32:47]
    buffer_load_dword v89, v4, s[4:7], s14 offen offset:2304 sc1
    ds_read_b64_tr_b16 a[116:117], v208 offset:25088
    ds_read_b64_tr_b16 a[118:119], v208 offset:26112
    s_waitcnt vmcnt(15) lgkmcnt(8)
    v_mfma_f32_32x32x16_bf16 v[16:31], a[128:131], a[40:43], v[16:31]
    buffer_load_dwordx4 a[72:75], v2, s[4:7], s11 offen offset:2048 sc1
    ds_read_b64_tr_b16 a[120:121], v208 offset:26624
    ds_read_b64_tr_b16 a[122:123], v208 offset:27648
    v_mfma_f32_32x32x16_bf16 v[32:47], a[132:135], a[40:43], v[32:47]
    buffer_load_dword v90, v4, s[4:7], s14 offen offset:2560 sc1
    ds_read_b64_tr_b16 a[124:125], v208 offset:27136
    ds_read_b64_tr_b16 a[126:127], v208 offset:28160
    s_waitcnt vmcnt(15) lgkmcnt(8)
    v_mfma_f32_32x32x16_bf16 v[16:31], a[136:139], a[44:47], v[16:31]
    buffer_load_dwordx4 a[76:79], v2, s[4:7], s11 offen offset:3072 sc1
    ds_read_b64_tr_b16 a[128:129], v208 offset:28672
    ds_read_b64_tr_b16 a[130:131], v208 offset:29696
    v_mfma_f32_32x32x16_bf16 v[32:47], a[140:143], a[44:47], v[32:47]
    buffer_load_dword v91, v4, s[4:7], s14 offen offset:2816 sc1
    ds_read_b64_tr_b16 a[132:133], v208 offset:29184
    ds_read_b64_tr_b16 a[134:135], v208 offset:30208
    s_waitcnt vmcnt(15) lgkmcnt(8)
    v_mfma_f32_32x32x16_bf16 v[16:31], a[112:115], a[48:51], v[16:31]
    s_add_u32 s11, s11, 4096
    buffer_load_dwordx4 a[80:83], v2, s[4:7], s11 offen offset:0 sc1
    ds_read_b64_tr_b16 a[136:137], v208 offset:30720
    ds_read_b64_tr_b16 a[138:139], v208 offset:31744
    v_mfma_f32_32x32x16_bf16 v[32:47], a[116:119], a[48:51], v[32:47]
    buffer_load_dword v92, v4, s[4:7], s14 offen offset:3072 sc1
    ds_read_b64_tr_b16 a[140:141], v208 offset:31232
    ds_read_b64_tr_b16 a[142:143], v208 offset:32256
    s_waitcnt vmcnt(15) lgkmcnt(8)
    v_mfma_f32_32x32x16_bf16 v[16:31], a[120:123], a[52:55], v[16:31]
    buffer_load_dwordx4 a[84:87], v2, s[4:7], s11 offen offset:1024 sc1
    ds_read_b64_tr_b16 a[112:113], v208 offset:32768
    ds_read_b64_tr_b16 a[114:115], v208 offset:33792
    v_mfma_f32_32x32x16_bf16 v[32:47], a[124:127], a[52:55], v[32:47]
    buffer_load_dword v93, v4, s[4:7], s14 offen offset:3328 sc1
    ds_read_b64_tr_b16 a[116:117], v208 offset:33280
    ds_read_b64_tr_b16 a[118:119], v208 offset:34304
    s_waitcnt vmcnt(15) lgkmcnt(8)
    v_mfma_f32_32x32x16_bf16 v[16:31], a[128:131], a[56:59], v[16:31]
    buffer_load_dwordx4 a[88:91], v2, s[4:7], s11 offen offset:2048 sc1
    ds_read_b64_tr_b16 a[120:121], v208 offset:34816
    ds_read_b64_tr_b16 a[122:123], v208 offset:35840
    v_mfma_f32_32x32x16_bf16 v[32:47], a[132:135], a[56:59], v[32:47]
    s_lshl_b32 s16, s2, 11
    s_add_u32 s16, s16, 2097152
    v_lshlrev_b32 v13, 3, v1
    buffer_load_dwordx2 v[230:231], v13, s[4:7], s16 offen offset:0 sc1
    ds_read_b64_tr_b16 a[124:125], v208 offset:35328
    ds_read_b64_tr_b16 a[126:127], v208 offset:36352
    s_waitcnt vmcnt(15) lgkmcnt(8)
    v_mfma_f32_32x32x16_bf16 v[16:31], a[136:139], a[60:63], v[16:31]
    buffer_load_dwordx4 a[92:95], v2, s[4:7], s11 offen offset:3072 sc1
    ds_read_b64_tr_b16 a[128:129], v208 offset:36864
    s_cbranch_execz L_walk
    ds_read_b64_tr_b16 a[130:131], v208 offset:37888
    v_mfma_f32_32x32x16_bf16 v[32:47], a[140:143], a[60:63], v[32:47]
    buffer_load_dwordx2 v[232:233], v13, s[4:7], s16 offen offset:512 sc1
    ds_read_b64_tr_b16 a[132:133], v208 offset:37376
    ds_read_b64_tr_b16 a[134:135], v208 offset:38400
    s_waitcnt vmcnt(15) lgkmcnt(8)
    v_mfma_f32_32x32x16_bf16 v[16:31], a[112:115], a[64:67], v[16:31]
    s_add_u32 s11, s11, 4096
    buffer_load_dwordx4 a[96:99], v2, s[4:7], s11 offen offset:0 sc1
    ds_read_b64_tr_b16 a[136:137], v208 offset:38912
    ds_read_b64_tr_b16 a[138:139], v208 offset:39936
    v_mfma_f32_32x32x16_bf16 v[32:47], a[116:119], a[64:67], v[32:47]
    buffer_load_dwordx2 v[234:235], v13, s[4:7], s16 offen offset:1024 sc1
    ds_read_b64_tr_b16 a[140:141], v208 offset:39424
    ds_read_b64_tr_b16 a[142:143], v208 offset:40448
    s_waitcnt vmcnt(15) lgkmcnt(8)
    v_mfma_f32_32x32x16_bf16 v[16:31], a[120:123], a[68:71], v[16:31]
    buffer_load_dwordx4 a[100:103], v2, s[4:7], s11 offen offset:1024 sc1
    ds_read_b64_tr_b16 a[112:113], v208 offset:40960
    ds_read_b64_tr_b16 a[114:115], v208 offset:41984
    v_mfma_f32_32x32x16_bf16 v[32:47], a[124:127], a[68:71], v[32:47]
    buffer_load_dwordx2 v[236:237], v13, s[4:7], s16 offen offset:1536 sc1
    ds_read_b64_tr_b16 a[116:117], v208 offset:41472
    ds_read_b64_tr_b16 a[118:119], v208 offset:42496
    s_waitcnt vmcnt(15) lgkmcnt(8)
    v_mfma_f32_32x32x16_bf16 v[16:31], a[128:131], a[72:75], v[16:31]
    buffer_load_dwordx4 a[104:107], v2, s[4:7], s11 offen offset:2048 sc1
    ds_read_b64_tr_b16 a[120:121], v208 offset:43008
    ds_read_b64_tr_b16 a[122:123], v208 offset:44032
    v_mfma_f32_32x32x16_bf16 v[32:47], a[132:135], a[72:75], v[32:47]
    ds_read_b64_tr_b16 a[124:125], v208 offset:43520
    ds_read_b64_tr_b16 a[126:127], v208 offset:44544
    s_waitcnt vmcnt(14) lgkmcnt(8)
    v_mfma_f32_32x32x16_bf16 v[16:31], a[136:139], a[76:79], v[16:31]
    buffer_load_dwordx4 a[108:111], v2, s[4:7], s11 offen offset:3072 sc1
    ds_read_b64_tr_b16 a[128:129], v208 offset:45056
    ds_read_b64_tr_b16 a[130:131], v208 offset:46080
    v_mfma_f32_32x32x16_bf16 v[32:47], a[140:143], a[76:79], v[32:47]
    ds_read_b64_tr_b16 a[132:133], v208 offset:45568
    ds_read_b64_tr_b16 a[134:135], v208 offset:46592
    s_waitcnt vmcnt(13) lgkmcnt(8)
    v_mfma_f32_32x32x16_bf16 v[16:31], a[112:115], a[80:83], v[16:31]
    s_waitcnt vmcnt(10)
    v_add_f32 v80, v80, v81
    v_add_f32 v82, v82, v83
    v_add_f32 v84, v84, v85
    ds_read_b64_tr_b16 a[136:137], v208 offset:47104
    ds_read_b64_tr_b16 a[138:139], v208 offset:48128
    v_mfma_f32_32x32x16_bf16 v[32:47], a[116:119], a[80:83], v[32:47]
    v_add_f32 v86, v86, v87
    v_add_f32 v88, v88, v89
    v_add_f32 v90, v90, v91
    ds_read_b64_tr_b16 a[140:141], v208 offset:47616
    ds_read_b64_tr_b16 a[142:143], v208 offset:48640
    s_waitcnt lgkmcnt(8)
    v_mfma_f32_32x32x16_bf16 v[16:31], a[120:123], a[84:87], v[16:31]
    v_add_f32 v92, v92, v93
    v_add_f32 v80, v80, v82
    v_add_f32 v84, v84, v86
    buffer_load_dwordx4 v[164:167], v7, s[4:7], s27 offen offset:2048 sc1
    ds_read_b64_tr_b16 a[112:113], v208 offset:49152
    ds_read_b64_tr_b16 a[114:115], v208 offset:50176
    v_mfma_f32_32x32x16_bf16 v[32:47], a[124:127], a[84:87], v[32:47]
    v_add_f32 v88, v88, v90
    v_add_f32 v80, v80, v84
    v_add_f32 v88, v88, v92
    ds_read_b64_tr_b16 a[116:117], v208 offset:49664
    ds_read_b64_tr_b16 a[118:119], v208 offset:50688
    s_waitcnt vmcnt(10) lgkmcnt(8)
    v_mfma_f32_32x32x16_bf16 v[16:31], a[128:131], a[88:91], v[16:31]
    v_add_f32 v80, v80, v88
    v_mul_f32 v80, 0x3b124925, v80
    v_mov_b32 v81, v80
    s_add_u32 s27, s27, 4096
    s_nop 0
    s_cbranch_execz L_walk
    buffer_load_dwordx4 v[168:171], v6, s[4:7], s27 offen offset:0 sc1
    ds_read_b64_tr_b16 a[120:121], v208 offset:51200
    ds_read_b64_tr_b16 a[122:123], v208 offset:52224
    v_mfma_f32_32x32x16_bf16 v[32:47], a[132:135], a[88:91], v[32:47]
    s_nop 1
    v_permlane32_swap_b32 v80, v81
    v_fma_f32 v82, -v80, v80, v81
    ds_read_b64_tr_b16 a[124:125], v208 offset:51712
    ds_read_b64_tr_b16 a[126:127], v208 offset:52736
    s_waitcnt vmcnt(9) lgkmcnt(8)
    v_mfma_f32_32x32x16_bf16 v[16:31], a[136:139], a[92:95], v[16:31]
    v_max_f32 v82, 0, v82
    v_add_f32 v82, 0x3727c5ac, v82
    v_rsq_f32 v12, v82
    buffer_load_dwordx4 v[172:175], v7, s[4:7], s27 offen offset:0 sc1
    ds_read_b64_tr_b16 a[128:129], v208 offset:53248
    ds_read_b64_tr_b16 a[130:131], v208 offset:54272
    v_mfma_f32_32x32x16_bf16 v[32:47], a[140:143], a[92:95], v[32:47]
    v_sub_f32 v80, 0, v80
    v_cvt_pk_bf16_f32 v83, v80, v80
    v_and_b32 v84, 0xffff0000, v83
    ds_read_b64_tr_b16 a[132:133], v208 offset:53760
    ds_read_b64_tr_b16 a[134:135], v208 offset:54784
    s_waitcnt vmcnt(8) lgkmcnt(8)
    v_mfma_f32_32x32x16_bf16 v[16:31], a[112:115], a[96:99], v[16:31]
    v_sub_f32 v84, v80, v84
    v_cvt_pk_bf16_f32 v84, v84, v84
    v_cndmask_b32 v238, 0, v83, s[20:21]
    buffer_load_dwordx4 v[176:179], v6, s[4:7], s27 offen offset:2048 sc1
    ds_read_b64_tr_b16 a[136:137], v208 offset:55296
    ds_read_b64_tr_b16 a[138:139], v208 offset:56320
    v_mfma_f32_32x32x16_bf16 v[32:47], a[116:119], a[96:99], v[32:47]
    v_cndmask_b32 v239, 0, v84, s[20:21]
    ds_read_b64_tr_b16 a[140:141], v208 offset:55808
    ds_read_b64_tr_b16 a[142:143], v208 offset:56832
    s_waitcnt vmcnt(7) lgkmcnt(8)
    v_mfma_f32_32x32x16_bf16 v[16:31], a[120:123], a[100:103], v[16:31]
    buffer_load_dwordx4 v[180:183], v7, s[4:7], s27 offen offset:2048 sc1
    v_mfma_f32_32x32x16_bf16 v[32:47], a[124:127], a[100:103], v[32:47]
    s_waitcnt vmcnt(6) lgkmcnt(4)
    v_mfma_f32_32x32x16_bf16 v[16:31], a[128:131], a[104:107], v[16:31]
    s_add_u32 s27, s27, 4096
    buffer_load_dwordx4 v[184:187], v6, s[4:7], s27 offen offset:0 sc1
    v_mfma_f32_32x32x16_bf16 v[32:47], a[132:135], a[104:107], v[32:47]
    s_lshl_b32 s19, s34, 11
    s_sub_u32 s19, s68, s19
    s_add_u32 s19, s19, 57344
    s_waitcnt vmcnt(6) lgkmcnt(0)
    v_mfma_f32_32x32x16_bf16 v[16:31], a[136:139], a[108:111], v[16:31]
    buffer_load_dwordx4 v[188:191], v7, s[4:7], s27 offen offset:0 sc1
    v_mfma_f32_32x32x16_bf16 v[32:47], a[140:143], a[108:111], v[32:47]
    v_add_u32 v208, 57344, v208
    v_mfma_f32_32x32x8_bf16 v[48:63], v[234:235], v[238:239], 0
    ds_read_b64_tr_b16 a[112:113], v208 offset:0
    ds_read_b64_tr_b16 a[114:115], v208 offset:1024
    ds_read_b64_tr_b16 a[116:117], v208 offset:2048
    ds_read_b64_tr_b16 a[118:119], v208 offset:3072
    ds_read_b64_tr_b16 a[120:121], v208 offset:4096
    ds_read_b64_tr_b16 a[122:123], v208 offset:5120
    ds_read_b64_tr_b16 a[124:125], v208 offset:6144
    ds_read_b64_tr_b16 a[126:127], v208 offset:7168
    ds_read_b64_tr_b16 a[128:129], v208 offset:8192
    ds_read_b64_tr_b16 a[130:131], v208 offset:9216
    v_mfma_f32_32x32x8_bf16 v[16:31], v[230:231], v[238:239], v[16:31]
    v_mfma_f32_32x32x8_bf16 v[32:47], v[232:233], v[238:239], v[32:47]
    v_mfma_f32_32x32x8_bf16 v[64:79], v[236:237], v[238:239], 0
    s_nop 9
    v_pk_mul_f32 v[16:17], v[16:17], v[12:13] op_sel_hi:[1,0]
    v_pk_mul_f32 v[18:19], v[18:19], v[12:13] op_sel_hi:[1,0]
    v_pk_mul_f32 v[20:21], v[20:21], v[12:13] op_sel_hi:[1,0]
    s_nop 0
    s_cbranch_execz L_walk
    v_pk_mul_f32 v[22:23], v[22:23], v[12:13] op_sel_hi:[1,0]
    v_pk_mul_f32 v[24:25], v[24:25], v[12:13] op_sel_hi:[1,0]
    v_pk_mul_f32 v[26:27], v[26:27], v[12:13] op_sel_hi:[1,0]
    v_pk_mul_f32 v[28:29], v[28:29], v[12:13] op_sel_hi:[1,0]
    v_pk_mul_f32 v[30:31], v[30:31], v[12:13] op_sel_hi:[1,0]
    v_cvt_pk_bf16_f32 v16, v16, v17
    v_cvt_pk_bf16_f32 v17, v18, v19
    v_cvt_pk_bf16_f32 v18, v20, v21
    v_cvt_pk_bf16_f32 v19, v22, v23
    v_cvt_pk_bf16_f32 v20, v24, v25
    v_cvt_pk_bf16_f32 v21, v26, v27
    v_cvt_pk_bf16_f32 v22, v28, v29
    v_cvt_pk_bf16_f32 v23, v30, v31
    v_pk_max_i16 v16, v16, 0
    v_pk_max_i16 v17, v17, 0
    v_pk_max_i16 v18, v18, 0
    v_pk_max_i16 v19, v19, 0
    v_pk_max_i16 v20, v20, 0
    v_pk_max_i16 v21, v21, 0
    v_pk_max_i16 v22, v22, 0
    v_pk_max_i16 v23, v23, 0
    buffer_store_dwordx4 v[16:19], v2, s[4:7], s68 offen offset:0 sc1
    buffer_store_dwordx4 v[20:23], v2, s[4:7], s68 offen offset:1024 sc1
    v_pk_mul_f32 v[32:33], v[32:33], v[12:13] op_sel_hi:[1,0]
    v_pk_mul_f32 v[34:35], v[34:35], v[12:13] op_sel_hi:[1,0]
    v_pk_mul_f32 v[36:37], v[36:37], v[12:13] op_sel_hi:[1,0]
    v_pk_mul_f32 v[38:39], v[38:39], v[12:13] op_sel_hi:[1,0]
    v_pk_mul_f32 v[40:41], v[40:41], v[12:13] op_sel_hi:[1,0]
    v_pk_mul_f32 v[42:43], v[42:43], v[12:13] op_sel_hi:[1,0]
    v_pk_mul_f32 v[44:45], v[44:45], v[12:13] op_sel_hi:[1,0]
    v_pk_mul_f32 v[46:47], v[46:47], v[12:13] op_sel_hi:[1,0]
    ds_read_b64_tr_b16 a[132:133], v208 offset:10240
    ds_read_b64_tr_b16 a[134:135], v208 offset:11264
    s_waitcnt lgkmcnt(8)
    v_mfma_f32_32x32x16_bf16 v[48:63], a[112:115], a[0:3], v[48:63]
    v_cvt_pk_bf16_f32 v32, v32, v33
    v_cvt_pk_bf16_f32 v33, v34, v35
    v_cvt_pk_bf16_f32 v34, v36, v37
    v_cvt_pk_bf16_f32 v35, v38, v39
    v_cvt_pk_bf16_f32 v36, v40, v41
    ds_read_b64_tr_b16 a[136:137], v208 offset:12288
    ds_read_b64_tr_b16 a[138:139], v208 offset:13312
    v_mfma_f32_32x32x16_bf16 v[48:63], a[116:119], a[4:7], v[48:63]
    v_cvt_pk_bf16_f32 v37, v42, v43
    v_cvt_pk_bf16_f32 v38, v44, v45
    v_cvt_pk_bf16_f32 v39, v46, v47
    v_pk_max_i16 v32, v32, 0
    v_pk_max_i16 v33, v33, 0
    ds_read_b64_tr_b16 a[140:141], v208 offset:14336
    ds_read_b64_tr_b16 a[142:143], v208 offset:15360
    s_waitcnt lgkmcnt(8)
    v_mfma_f32_32x32x16_bf16 v[48:63], a[120:123], a[8:11], v[48:63]
    v_pk_max_i16 v34, v34, 0
    v_pk_max_i16 v35, v35, 0
    v_pk_max_i16 v36, v36, 0
    v_pk_max_i16 v37, v37, 0
    v_pk_max_i16 v38, v38, 0
    ds_read_b64_tr_b16 a[112:113], v208 offset:16384
    ds_read_b64_tr_b16 a[114:115], v208 offset:17408
    v_mfma_f32_32x32x16_bf16 v[48:63], a[124:127], a[12:15], v[48:63]
    v_pk_max_i16 v39, v39, 0
    buffer_store_dwordx4 v[32:35], v2, s[4:7], s68 offen offset:2048 sc1
    buffer_store_dwordx4 v[36:39], v2, s[4:7], s68 offen offset:3072 sc1
    ds_read_b64_tr_b16 a[116:117], v208 offset:18432
    s_nop 0
    s_cbranch_execz L_walk
    ds_read_b64_tr_b16 a[118:119], v208 offset:19456
    s_waitcnt lgkmcnt(8)
    v_mfma_f32_32x32x16_bf16 v[48:63], a[128:131], a[16:19], v[48:63]
    s_lshl_b32 s41, s3, 10
    s_add_u32 s40, s41, s77
    ds_read_b64_tr_b16 a[120:121], v208 offset:20480
    ds_read_b64_tr_b16 a[122:123], v208 offset:21504
    v_mfma_f32_32x32x16_bf16 v[48:63], a[132:135], a[20:23], v[48:63]
    buffer_load_dwordx4 v[192:195], v6, s[4:7], s27 offen offset:2048 sc1
    ds_read_b64_tr_b16 a[124:125], v208 offset:22528
    ds_read_b64_tr_b16 a[126:127], v208 offset:23552
    s_waitcnt lgkmcnt(8)
    v_mfma_f32_32x32x16_bf16 v[48:63], a[136:139], a[24:27], v[48:63]
    ds_read_b64_tr_b16 a[128:129], v208 offset:24576
    ds_read_b64_tr_b16 a[130:131], v208 offset:25600
    v_mfma_f32_32x32x16_bf16 v[48:63], a[140:143], a[28:31], v[48:63]
    buffer_load_dwordx4 v[196:199], v7, s[4:7], s27 offen offset:2048 sc1
    ds_read_b64_tr_b16 a[132:133], v208 offset:26624
    ds_read_b64_tr_b16 a[134:135], v208 offset:27648
    s_waitcnt lgkmcnt(8)
    v_mfma_f32_32x32x16_bf16 v[48:63], a[112:115], a[32:35], v[48:63]
    ds_read_b64_tr_b16 a[136:137], v208 offset:28672
    ds_read_b64_tr_b16 a[138:139], v208 offset:29696
    v_mfma_f32_32x32x16_bf16 v[48:63], a[116:119], a[36:39], v[48:63]
    s_add_u32 s27, s27, 4096
    buffer_load_dwordx4 v[200:203], v6, s[4:7], s27 offen offset:0 sc1
    ds_read_b64_tr_b16 a[140:141], v208 offset:30720
    ds_read_b64_tr_b16 a[142:143], v208 offset:31744
    s_waitcnt lgkmcnt(8)
    v_mfma_f32_32x32x16_bf16 v[48:63], a[120:123], a[40:43], v[48:63]
    ds_read_b64_tr_b16 a[112:113], v208 offset:32768
    ds_read_b64_tr_b16 a[114:115], v208 offset:33792
    v_mfma_f32_32x32x16_bf16 v[48:63], a[124:127], a[44:47], v[48:63]
    buffer_load_dwordx4 v[204:207], v7, s[4:7], s27 offen offset:0 sc1
    ds_read_b64_tr_b16 a[116:117], v208 offset:34816
    ds_read_b64_tr_b16 a[118:119], v208 offset:35840
    s_waitcnt lgkmcnt(8)
    v_mfma_f32_32x32x16_bf16 v[48:63], a[128:131], a[48:51], v[48:63]
    ds_read_b64_tr_b16 a[120:121], v208 offset:36864
    ds_read_b64_tr_b16 a[122:123], v208 offset:37888
    v_mfma_f32_32x32x16_bf16 v[48:63], a[132:135], a[52:55], v[48:63]
    ds_read_b64_tr_b16 a[124:125], v208 offset:38912
    ds_read_b64_tr_b16 a[126:127], v208 offset:39936
    s_waitcnt lgkmcnt(8)
    v_mfma_f32_32x32x16_bf16 v[48:63], a[136:139], a[56:59], v[48:63]
    ds_read_b64_tr_b16 a[128:129], v208 offset:40960
    ds_read_b64_tr_b16 a[130:131], v208 offset:41984
    v_mfma_f32_32x32x16_bf16 v[48:63], a[140:143], a[60:63], v[48:63]
    ds_read_b64_tr_b16 a[132:133], v208 offset:43008
    ds_read_b64_tr_b16 a[134:135], v208 offset:44032
    s_waitcnt lgkmcnt(8)
    v_mfma_f32_32x32x16_bf16 v[48:63], a[112:115], a[64:67], v[48:63]
    ds_read_b64_tr_b16 a[136:137], v208 offset:45056
    ds_read_b64_tr_b16 a[138:139], v208 offset:46080
    v_mfma_f32_32x32x16_bf16 v[48:63], a[116:119], a[68:71], v[48:63]
    ds_read_b64_tr_b16 a[140:141], v208 offset:47104
    ds_read_b64_tr_b16 a[142:143], v208 offset:48128
    s_waitcnt lgkmcnt(8)
    v_mfma_f32_32x32x16_bf16 v[48:63], a[120:123], a[72:75], v[48:63]
    ds_read_b64_tr_b16 a[112:113], v208 offset:49152
    ds_read_b64_tr_b16 a[114:115], v208 offset:50176
    v_mfma_f32_32x32x16_bf16 v[48:63], a[124:127], a[76:79], v[48:63]
    ds_read_b64_tr_b16 a[116:117], v208 offset:51200
    ds_read_b64_tr_b16 a[118:119], v208 offset:52224
    s_waitcnt lgkmcnt(8)
    v_mfma_f32_32x32x16_bf16 v[48:63], a[128:131], a[80:83], v[48:63]
    ds_read_b64_tr_b16 a[120:121], v208 offset:53248
    ds_read_b64_tr_b16 a[122:123], v208 offset:54272
    v_mfma_f32_32x32x16_bf16 v[48:63], a[132:135], a[84:87], v[48:63]
    s_cbranch_execz L_walk
    ds_read_b64_tr_b16 a[124:125], v208 offset:55296
    ds_read_b64_tr_b16 a[126:127], v208 offset:56320
    s_waitcnt lgkmcnt(8)
    v_mfma_f32_32x32x16_bf16 v[48:63], a[136:139], a[88:91], v[48:63]
    ds_read_b64_tr_b16 a[128:129], v208 offset:512
    ds_read_b64_tr_b16 a[130:131], v208 offset:1536
    v_mfma_f32_32x32x16_bf16 v[48:63], a[140:143], a[92:95], v[48:63]
    ds_read_b64_tr_b16 a[132:133], v208 offset:2560
    ds_read_b64_tr_b16 a[134:135], v208 offset:3584
    s_waitcnt lgkmcnt(8)
    v_mfma_f32_32x32x16_bf16 v[48:63], a[112:115], a[96:99], v[48:63]
    ds_read_b64_tr_b16 a[136:137], v208 offset:4608
    ds_read_b64_tr_b16 a[138:139], v208 offset:5632
    v_mfma_f32_32x32x16_bf16 v[48:63], a[116:119], a[100:103], v[48:63]
    ds_read_b64_tr_b16 a[140:141], v208 offset:6656
    ds_read_b64_tr_b16 a[142:143], v208 offset:7680
    s_waitcnt lgkmcnt(8)
    v_mfma_f32_32x32x16_bf16 v[48:63], a[120:123], a[104:107], v[48:63]
    s_waitcnt vmcnt(4)
    s_add_u32 s24, s32, s17
    s_mov_b64 exec, 1
    s_cmp_lg_u32 s35, 0
    s_cbranch_scc1 L_hs10
    buffer_store_dwordx2 v[214:215], off, s[4:7], s24 offset:1024
L_hb10:
    s_mov_b64 exec, -1
    ds_read_b64_tr_b16 a[112:113], v208 offset:8704
    ds_read_b64_tr_b16 a[114:115], v208 offset:9728
    v_mfma_f32_32x32x16_bf16 v[48:63], a[124:127], a[108:111], v[48:63]
    ds_read_b64_tr_b16 a[116:117], v208 offset:10752
    ds_read_b64_tr_b16 a[118:119], v208 offset:11776
    s_waitcnt lgkmcnt(8)
    v_mfma_f32_32x32x16_bf16 v[64:79], a[128:131], a[0:3], v[64:79]
    ds_read_b64_tr_b16 a[120:121], v208 offset:12800
    ds_read_b64_tr_b16 a[122:123], v208 offset:13824
    v_mfma_f32_32x32x16_bf16 v[64:79], a[132:135], a[4:7], v[64:79]
    ds_read_b64_tr_b16 a[124:125], v208 offset:14848
    ds_read_b64_tr_b16 a[126:127], v208 offset:15872
    s_waitcnt lgkmcnt(8)
    v_mfma_f32_32x32x16_bf16 v[64:79], a[136:139], a[8:11], v[64:79]
    ds_read_b64_tr_b16 a[128:129], v208 offset:16896
    ds_read_b64_tr_b16 a[130:131], v208 offset:17920
    v_mfma_f32_32x32x16_bf16 v[64:79], a[140:143], a[12:15], v[64:79]
    v_mul_f32 v48, v12, v48
    v_mul_f32 v49, v12, v49
    v_mul_f32 v50, v12, v50
    ds_read_b64_tr_b16 a[132:133], v208 offset:18944
    ds_read_b64_tr_b16 a[134:135], v208 offset:19968
    s_waitcnt lgkmcnt(8)
    v_mfma_f32_32x32x16_bf16 v[64:79], a[112:115], a[16:19], v[64:79]
    v_mul_f32 v51, v12, v51
    v_mul_f32 v52, v12, v52
    v_mul_f32 v53, v12, v53
    ds_read_b64_tr_b16 a[136:137], v208 offset:20992
    ds_read_b64_tr_b16 a[138:139], v208 offset:22016
    v_mfma_f32_32x32x16_bf16 v[64:79], a[116:119], a[20:23], v[64:79]
    v_mul_f32 v54, v12, v54
    v_mul_f32 v55, v12, v55
    v_mul_f32 v56, v12, v56
    ds_read_b64_tr_b16 a[140:141], v208 offset:23040
    ds_read_b64_tr_b16 a[142:143], v208 offset:24064
    s_waitcnt lgkmcnt(8)
    v_mfma_f32_32x32x16_bf16 v[64:79], a[120:123], a[24:27], v[64:79]
    v_mul_f32 v57, v12, v57
    v_mul_f32 v58, v12, v58
    v_mul_f32 v59, v12, v59
    ds_read_b64_tr_b16 a[112:113], v208 offset:25088
    ds_read_b64_tr_b16 a[114:115], v208 offset:26112
    v_mfma_f32_32x32x16_bf16 v[64:79], a[124:127], a[28:31], v[64:79]
    v_mul_f32 v60, v12, v60
    v_mul_f32 v61, v12, v61
    v_mul_f32 v62, v12, v62
    ds_read_b64_tr_b16 a[116:117], v208 offset:27136
    ds_read_b64_tr_b16 a[118:119], v208 offset:28160
    s_waitcnt lgkmcnt(8)
    v_mfma_f32_32x32x16_bf16 v[64:79], a[128:131], a[32:35], v[64:79]
    v_mul_f32 v63, v12, v63
    v_cvt_pk_bf16_f32 v48, v48, v49
    v_cvt_pk_bf16_f32 v49, v50, v51
    s_nop 0
    s_cbranch_execz L_walk
    ds_read_b64_tr_b16 a[120:121], v208 offset:29184
    ds_read_b64_tr_b16 a[122:123], v208 offset:30208
    v_mfma_f32_32x32x16_bf16 v[64:79], a[132:135], a[36:39], v[64:79]
    v_cvt_pk_bf16_f32 v50, v52, v53
    v_cvt_pk_bf16_f32 v51, v54, v55
    v_cvt_pk_bf16_f32 v52, v56, v57
    ds_read_b64_tr_b16 a[124:125], v208 offset:31232
    ds_read_b64_tr_b16 a[126:127], v208 offset:32256
    s_waitcnt lgkmcnt(8)
    v_mfma_f32_32x32x16_bf16 v[64:79], a[136:139], a[40:43], v[64:79]
    v_cvt_pk_bf16_f32 v53, v58, v59
    v_cvt_pk_bf16_f32 v54, v60, v61
    v_cvt_pk_bf16_f32 v55, v62, v63
    buffer_load_dwordx2 v[14:15], v212, s[4:7], s32 offen offset:1024 sc1
    ds_read_b64_tr_b16 a[128:129], v208 offset:33280
    ds_read_b64_tr_b16 a[130:131], v208 offset:34304
    v_mfma_f32_32x32x16_bf16 v[64:79], a[140:143], a[44:47], v[64:79]
    v_pk_max_i16 v48, v48, 0
    v_pk_max_i16 v49, v49, 0
    v_pk_max_i16 v50, v50, 0
    ds_read_b64_tr_b16 a[132:133], v208 offset:35328
    ds_read_b64_tr_b16 a[134:135], v208 offset:36352
    s_waitcnt lgkmcnt(8)
    v_mfma_f32_32x32x16_bf16 v[64:79], a[112:115], a[48:51], v[64:79]
    v_pk_max_i16 v51, v51, 0
    v_pk_max_i16 v52, v52, 0
    v_pk_max_i16 v53, v53, 0
    ds_read_b64_tr_b16 a[136:137], v208 offset:37376
    ds_read_b64_tr_b16 a[138:139], v208 offset:38400
    v_mfma_f32_32x32x16_bf16 v[64:79], a[116:119], a[52:55], v[64:79]
    v_pk_max_i16 v54, v54, 0
    v_pk_max_i16 v55, v55, 0
    buffer_store_dwordx4 v[48:51], v2, s[4:7], s19 offen offset:0 sc1
    buffer_store_dwordx4 v[52:55], v2, s[4:7], s19 offen offset:1024 sc1
    s_add_u32 s19, s19, 28672
    ds_read_b64_tr_b16 a[140:141], v208 offset:39424
    ds_read_b64_tr_b16 a[142:143], v208 offset:40448
    s_waitcnt lgkmcnt(8)
    v_mfma_f32_32x32x16_bf16 v[64:79], a[120:123], a[56:59], v[64:79]
    ds_read_b64_tr_b16 a[112:113], v208 offset:41472
    ds_read_b64_tr_b16 a[114:115], v208 offset:42496
    v_mfma_f32_32x32x16_bf16 v[64:79], a[124:127], a[60:63], v[64:79]
    s_mov_b32 s11, s71
    s_mov_b32 s12, s72
    ds_read_b64_tr_b16 a[116:117], v208 offset:43520
    ds_read_b64_tr_b16 a[118:119], v208 offset:44544
    s_waitcnt lgkmcnt(8)
    v_mfma_f32_32x32x16_bf16 v[64:79], a[128:131], a[64:67], v[64:79]
    s_waitcnt vmcnt(2)
    v_cmp_ne_u64 vcc, s[42:43], v[14:15]
    s_cbranch_vccnz L_pl11
L_pb11:
    buffer_load_dwordx4 a[0:3], v2, s[4:7], s11 offen offset:0 sc1
    ds_read_b64_tr_b16 a[120:121], v208 offset:45568
    ds_read_b64_tr_b16 a[122:123], v208 offset:46592
    v_mfma_f32_32x32x16_bf16 v[64:79], a[132:135], a[68:71], v[64:79]
    buffer_load_dwordx4 a[4:7], v2, s[4:7], s12 offen offset:0 sc1
    ds_read_b64_tr_b16 a[124:125], v208 offset:47616
    ds_read_b64_tr_b16 a[126:127], v208 offset:48640
    s_waitcnt lgkmcnt(8)
    v_mfma_f32_32x32x16_bf16 v[64:79], a[136:139], a[72:75], v[64:79]
    ds_read_b64_tr_b16 a[128:129], v208 offset:49664
    ds_read_b64_tr_b16 a[130:131], v208 offset:50688
    v_mfma_f32_32x32x16_bf16 v[64:79], a[140:143], a[76:79], v[64:79]
    buffer_load_dwordx4 a[8:11], v2, s[4:7], s11 offen offset:1024 sc1
    ds_read_b64_tr_b16 a[132:133], v208 offset:51712
    ds_read_b64_tr_b16 a[134:135], v208 offset:52736
    s_waitcnt lgkmcnt(8)
    v_mfma_f32_32x32x16_bf16 v[64:79], a[112:115], a[80:83], v[64:79]
    buffer_load_dwordx4 a[12:15], v2, s[4:7], s12 offen offset:1024 sc1
    s_cbranch_execz L_walk
    ds_read_b64_tr_b16 a[136:137], v208 offset:53760
    ds_read_b64_tr_b16 a[138:139], v208 offset:54784
    v_mfma_f32_32x32x16_bf16 v[64:79], a[116:119], a[84:87], v[64:79]
    ds_read_b64_tr_b16 a[140:141], v208 offset:55808
    ds_read_b64_tr_b16 a[142:143], v208 offset:56832
    s_waitcnt lgkmcnt(8)
    v_mfma_f32_32x32x16_bf16 v[64:79], a[120:123], a[88:91], v[64:79]
    buffer_load_dwordx4 a[16:19], v2, s[4:7], s11 offen offset:2048 sc1
    v_mfma_f32_32x32x16_bf16 v[64:79], a[124:127], a[92:95], v[64:79]
    buffer_load_dwordx4 a[20:23], v2, s[4:7], s12 offen offset:2048 sc1
    s_waitcnt lgkmcnt(4)
    v_mfma_f32_32x32x16_bf16 v[64:79], a[128:131], a[96:99], v[64:79]
    v_mfma_f32_32x32x16_bf16 v[64:79], a[132:135], a[100:103], v[64:79]
    buffer_load_dwordx4 a[24:27], v2, s[4:7], s11 offen offset:3072 sc1
    s_waitcnt lgkmcnt(0)
    v_mfma_f32_32x32x16_bf16 v[64:79], a[136:139], a[104:107], v[64:79]
    buffer_load_dwordx4 a[28:31], v2, s[4:7], s12 offen offset:3072 sc1
    v_mfma_f32_32x32x16_bf16 v[64:79], a[140:143], a[108:111], v[64:79]
    s_add_u32 s11, s11, 4096
    s_add_u32 s12, s12, 4096
    buffer_load_dwordx4 a[32:35], v2, s[4:7], s11 offen offset:0 sc1
    buffer_load_dwordx4 a[36:39], v2, s[4:7], s12 offen offset:0 sc1
    s_nop 9
    v_pk_mul_f32 v[64:65], v[64:65], v[12:13] op_sel_hi:[1,0]
    v_pk_mul_f32 v[66:67], v[66:67], v[12:13] op_sel_hi:[1,0]
    v_pk_mul_f32 v[68:69], v[68:69], v[12:13] op_sel_hi:[1,0]
    v_pk_mul_f32 v[70:71], v[70:71], v[12:13] op_sel_hi:[1,0]
    v_pk_mul_f32 v[72:73], v[72:73], v[12:13] op_sel_hi:[1,0]
    v_pk_mul_f32 v[74:75], v[74:75], v[12:13] op_sel_hi:[1,0]
    v_pk_mul_f32 v[76:77], v[76:77], v[12:13] op_sel_hi:[1,0]
    v_pk_mul_f32 v[78:79], v[78:79], v[12:13] op_sel_hi:[1,0]
    v_cvt_pk_bf16_f32 v80, v64, v65
    buffer_load_dwordx4 a[40:43], v2, s[4:7], s11 offen offset:1024 sc1
    v_cvt_pk_bf16_f32 v81, v66, v67
    v_cvt_pk_bf16_f32 v82, v68, v69
    v_cvt_pk_bf16_f32 v83, v70, v71
    v_cvt_pk_bf16_f32 v84, v72, v73
    v_cvt_pk_bf16_f32 v85, v74, v75
    v_cvt_pk_bf16_f32 v86, v76, v77
    v_cvt_pk_bf16_f32 v87, v78, v79
    v_pk_max_i16 v80, v80, 0
    v_pk_max_i16 v81, v81, 0
    v_pk_max_i16 v82, v82, 0
    v_pk_max_i16 v83, v83, 0
    v_pk_max_i16 v84, v84, 0
    buffer_load_dwordx4 a[44:47], v2, s[4:7], s12 offen offset:1024 sc1
    v_pk_max_i16 v85, v85, 0
    v_pk_max_i16 v86, v86, 0
    v_pk_max_i16 v87, v87, 0
    buffer_store_dwordx4 v[80:83], v2, s[4:7], s19 offen offset:0 sc1
    buffer_store_dwordx4 v[84:87], v2, s[4:7], s19 offen offset:1024 sc1
    s_waitcnt vmcnt(12)
    v_mfma_f32_32x32x16_bf16 v[16:31], a[144:147], a[0:3], v[240:255]
    buffer_load_dwordx4 a[48:51], v2, s[4:7], s11 offen offset:2048 sc1
    v_mfma_f32_32x32x16_bf16 v[32:47], a[144:147], a[4:7], 0
    v_mfma_f32_32x32x16_bf16 v[48:63], a[148:151], a[0:3], 0
    buffer_load_dwordx4 a[52:55], v2, s[4:7], s12 offen offset:2048 sc1
    v_mfma_f32_32x32x16_bf16 v[64:79], a[148:151], a[4:7], 0
    s_add_u32 s24, s32, s17
    s_mov_b64 exec, 1
    s_cmp_lg_u32 s35, 0
    s_cbranch_scc1 L_hs12
    buffer_store_dwordx2 v[214:215], off, s[4:7], s24 offset:1536
L_hb12:
    s_mov_b64 exec, -1
    s_waitcnt vmcnt(13)
    v_mfma_f32_32x32x16_bf16 v[16:31], a[152:155], a[8:11], v[16:31]
    buffer_load_dwordx4 a[56:59], v2, s[4:7], s11 offen offset:3072 sc1
    v_mfma_f32_32x32x16_bf16 v[32:47], a[152:155], a[12:15], v[32:47]
    v_mfma_f32_32x32x16_bf16 v[48:63], a[156:159], a[8:11], v[48:63]
    s_cbranch_execz L_walk
    buffer_load_dwordx4 a[60:63], v2, s[4:7], s12 offen offset:3072 sc1
    v_mfma_f32_32x32x16_bf16 v[64:79], a[156:159], a[12:15], v[64:79]
    s_waitcnt vmcnt(13)
    v_mfma_f32_32x32x16_bf16 v[16:31], a[160:163], a[16:19], v[16:31]
    s_add_u32 s11, s11, 4096
    s_add_u32 s12, s12, 4096
    buffer_load_dwordx4 a[64:67], v2, s[4:7], s11 offen offset:0 sc1
    v_mfma_f32_32x32x16_bf16 v[32:47], a[160:163], a[20:23], v[32:47]
    v_mfma_f32_32x32x16_bf16 v[48:63], a[164:167], a[16:19], v[48:63]
    buffer_load_dwordx4 a[68:71], v2, s[4:7], s12 offen offset:0 sc1
    v_mfma_f32_32x32x16_bf16 v[64:79], a[164:167], a[20:23], v[64:79]
    s_barrier
    s_waitcnt vmcnt(13)
    v_mfma_f32_32x32x16_bf16 v[16:31], a[168:171], a[24:27], v[16:31]
    buffer_load_dwordx4 a[72:75], v2, s[4:7], s11 offen offset:1024 sc1
    v_mfma_f32_32x32x16_bf16 v[32:47], a[168:171], a[28:31], v[32:47]
    v_mfma_f32_32x32x16_bf16 v[48:63], a[172:175], a[24:27], v[48:63]
    buffer_load_dwordx4 a[76:79], v2, s[4:7], s12 offen offset:1024 sc1
    v_mfma_f32_32x32x16_bf16 v[64:79], a[172:175], a[28:31], v[64:79]
    s_waitcnt vmcnt(13)
    v_mfma_f32_32x32x16_bf16 v[16:31], a[176:179], a[32:35], v[16:31]
    buffer_load_dwordx4 a[80:83], v2, s[4:7], s11 offen offset:2048 sc1
    v_mfma_f32_32x32x16_bf16 v[32:47], a[176:179], a[36:39], v[32:47]
    v_mfma_f32_32x32x16_bf16 v[48:63], a[180:183], a[32:35], v[48:63]
    buffer_load_dwordx4 a[84:87], v2, s[4:7], s12 offen offset:2048 sc1
    v_mfma_f32_32x32x16_bf16 v[64:79], a[180:183], a[36:39], v[64:79]
    s_waitcnt vmcnt(13)
    v_mfma_f32_32x32x16_bf16 v[16:31], a[184:187], a[40:43], v[16:31]
    buffer_load_dwordx4 a[88:91], v2, s[4:7], s11 offen offset:3072 sc1
    v_mfma_f32_32x32x16_bf16 v[32:47], a[184:187], a[44:47], v[32:47]
    v_mfma_f32_32x32x16_bf16 v[48:63], a[188:191], a[40:43], v[48:63]
    buffer_load_dwordx4 a[92:95], v2, s[4:7], s12 offen offset:3072 sc1
    v_mfma_f32_32x32x16_bf16 v[64:79], a[188:191], a[44:47], v[64:79]
    buffer_load_dwordx2 v[14:15], v212, s[4:7], s32 offen offset:1536 sc1
    s_waitcnt vmcnt(12)
    v_mfma_f32_32x32x16_bf16 v[16:31], a[192:195], a[48:51], v[16:31]
    s_add_u32 s11, s11, 4096
    s_add_u32 s12, s12, 4096
    buffer_load_dwordx4 a[96:99], v2, s[4:7], s11 offen offset:0 sc1
    v_mfma_f32_32x32x16_bf16 v[32:47], a[192:195], a[52:55], v[32:47]
    v_mfma_f32_32x32x16_bf16 v[48:63], a[196:199], a[48:51], v[48:63]
    buffer_load_dwordx4 a[100:103], v2, s[4:7], s12 offen offset:0 sc1
    v_mfma_f32_32x32x16_bf16 v[64:79], a[196:199], a[52:55], v[64:79]
    s_add_u32 s24, s32, s17
    s_mov_b64 exec, 1
    s_cmp_lg_u32 s35, 0
    s_cbranch_scc1 L_hs13
    buffer_store_dwordx2 v[214:215], off, s[4:7], s24 offset:3072
L_hb13:
    s_mov_b64 exec, -1
    s_waitcnt vmcnt(12)
    v_mfma_f32_32x32x16_bf16 v[16:31], a[200:203], a[56:59], v[16:31]
    buffer_load_dwordx4 a[104:107], v2, s[4:7], s11 offen offset:1024 sc1
    v_mfma_f32_32x32x16_bf16 v[32:47], a[200:203], a[60:63], v[32:47]
    v_mfma_f32_32x32x16_bf16 v[48:63], a[204:207], a[56:59], v[48:63]
    buffer_load_dwordx4 a[108:111], v2, s[4:7], s12 offen offset:1024 sc1
    v_mfma_f32_32x32x16_bf16 v[64:79], a[204:207], a[60:63], v[64:79]
    s_waitcnt vmcnt(5)
    v_cmp_ne_u64 vcc, s[42:43], v[14:15]
    s_cbranch_vccnz L_pl14
L_pb14:
    v_mfma_f32_32x32x16_bf16 v[16:31], a[208:211], a[64:67], v[16:31]
    s_mul_i32 s16, s3, 7168
    s_sub_u32 s11, s71, s16
    s_sub_u32 s12, s72, s16
    s_add_u32 s11, s11, 57344
    s_add_u32 s12, s12, 57344
    buffer_load_dwordx4 a[0:3], v2, s[4:7], s11 offen offset:0 sc1
    v_mfma_f32_32x32x16_bf16 v[32:47], a[208:211], a[68:71], v[32:47]
    v_mfma_f32_32x32x16_bf16 v[48:63], a[212:215], a[64:67], v[48:63]
    buffer_load_dwordx4 a[4:7], v2, s[4:7], s12 offen offset:0 sc1
    v_mfma_f32_32x32x16_bf16 v[64:79], a[212:215], a[68:71], v[64:79]
    v_mfma_f32_32x32x16_bf16 v[16:31], a[216:219], a[72:75], v[16:31]
    buffer_load_dwordx4 a[8:11], v2, s[4:7], s11 offen offset:1024 sc1
    s_cbranch_execz L_walk
    v_mfma_f32_32x32x16_bf16 v[32:47], a[216:219], a[76:79], v[32:47]
    v_mfma_f32_32x32x16_bf16 v[48:63], a[220:223], a[72:75], v[48:63]
    buffer_load_dwordx4 a[12:15], v2, s[4:7], s12 offen offset:1024 sc1
    v_mfma_f32_32x32x16_bf16 v[64:79], a[220:223], a[76:79], v[64:79]
    v_mfma_f32_32x32x16_bf16 v[16:31], a[224:227], a[80:83], v[16:31]
    buffer_load_dwordx4 a[16:19], v2, s[4:7], s11 offen offset:2048 sc1
    v_mfma_f32_32x32x16_bf16 v[32:47], a[224:227], a[84:87], v[32:47]
    v_mfma_f32_32x32x16_bf16 v[48:63], a[228:231], a[80:83], v[48:63]
    buffer_load_dwordx4 a[20:23], v2, s[4:7], s12 offen offset:2048 sc1
    v_mfma_f32_32x32x16_bf16 v[64:79], a[228:231], a[84:87], v[64:79]
    v_mfma_f32_32x32x16_bf16 v[16:31], a[232:235], a[88:91], v[16:31]
    buffer_load_dwordx4 a[24:27], v2, s[4:7], s11 offen offset:3072 sc1
    v_mfma_f32_32x32x16_bf16 v[32:47], a[232:235], a[92:95], v[32:47]
    v_mfma_f32_32x32x16_bf16 v[48:63], a[236:239], a[88:91], v[48:63]
    buffer_load_dwordx4 a[28:31], v2, s[4:7], s12 offen offset:3072 sc1
    v_mfma_f32_32x32x16_bf16 v[64:79], a[236:239], a[92:95], v[64:79]
    buffer_load_dwordx2 v[14:15], v212, s[4:7], s32 offen offset:3072 sc1
    s_waitcnt vmcnt(12)
    v_mfma_f32_32x32x16_bf16 v[16:31], a[240:243], a[96:99], v[16:31]
    s_add_u32 s11, s11, 4096
    s_add_u32 s12, s12, 4096
    buffer_load_dwordx4 a[32:35], v2, s[4:7], s11 offen offset:0 sc1
    v_mfma_f32_32x32x16_bf16 v[32:47], a[240:243], a[100:103], v[32:47]
    v_mfma_f32_32x32x16_bf16 v[48:63], a[244:247], a[96:99], v[48:63]
    buffer_load_dwordx4 a[36:39], v2, s[4:7], s12 offen offset:0 sc1
    v_mfma_f32_32x32x16_bf16 v[64:79], a[244:247], a[100:103], v[64:79]
    s_waitcnt vmcnt(11)
    v_mfma_f32_32x32x16_bf16 v[16:31], a[248:251], a[104:107], v[16:31]
    buffer_load_dwordx4 a[40:43], v2, s[4:7], s11 offen offset:1024 sc1
    v_mfma_f32_32x32x16_bf16 v[32:47], a[248:251], a[108:111], v[32:47]
    v_mfma_f32_32x32x16_bf16 v[48:63], a[252:255], a[104:107], v[48:63]
    buffer_load_dwordx4 a[44:47], v2, s[4:7], s12 offen offset:1024 sc1
    v_mfma_f32_32x32x16_bf16 v[64:79], a[252:255], a[108:111], v[64:79]
    s_waitcnt vmcnt(4)
    v_cmp_ne_u64 vcc, s[42:43], v[14:15]
    s_cbranch_vccnz L_pl15
L_pb15:
    v_mfma_f32_32x32x16_bf16 v[16:31], v[96:99], a[0:3], v[16:31]
    buffer_load_dwordx4 a[48:51], v2, s[4:7], s11 offen offset:2048 sc1
    v_mfma_f32_32x32x16_bf16 v[32:47], v[96:99], a[4:7], v[32:47]
    v_mfma_f32_32x32x16_bf16 v[48:63], v[100:103], a[0:3], v[48:63]
    buffer_load_dwordx4 a[52:55], v2, s[4:7], s12 offen offset:2048 sc1
    v_mfma_f32_32x32x16_bf16 v[64:79], v[100:103], a[4:7], v[64:79]
    v_mfma_f32_32x32x16_bf16 v[16:31], v[104:107], a[8:11], v[16:31]
    s_add_u32 s11, s11, 24576
    s_add_u32 s12, s12, 24576
    buffer_load_dwordx4 a[56:59], v2, s[4:7], s11 offen offset:0 sc1
    v_mfma_f32_32x32x16_bf16 v[32:47], v[104:107], a[12:15], v[32:47]
    v_mfma_f32_32x32x16_bf16 v[48:63], v[108:111], a[8:11], v[48:63]
    buffer_load_dwordx4 a[60:63], v2, s[4:7], s12 offen offset:0 sc1
    v_mfma_f32_32x32x16_bf16 v[64:79], v[108:111], a[12:15], v[64:79]
    v_mfma_f32_32x32x16_bf16 v[16:31], v[112:115], a[16:19], v[16:31]
    buffer_load_dwordx4 a[64:67], v2, s[4:7], s11 offen offset:1024 sc1
    v_mfma_f32_32x32x16_bf16 v[32:47], v[112:115], a[20:23], v[32:47]
    v_mfma_f32_32x32x16_bf16 v[48:63], v[116:119], a[16:19], v[48:63]
    buffer_load_dwordx4 a[68:71], v2, s[4:7], s12 offen offset:1024 sc1
    v_mfma_f32_32x32x16_bf16 v[64:79], v[116:119], a[20:23], v[64:79]
    v_mfma_f32_32x32x16_bf16 v[16:31], v[120:123], a[24:27], v[16:31]
    buffer_load_dwordx4 a[72:75], v2, s[4:7], s11 offen offset:2048 sc1
    v_mfma_f32_32x32x16_bf16 v[32:47], v[120:123], a[28:31], v[32:47]
    v_mfma_f32_32x32x16_bf16 v[48:63], v[124:127], a[24:27], v[48:63]
    buffer_load_dwordx4 a[76:79], v2, s[4:7], s12 offen offset:2048 sc1
    v_mfma_f32_32x32x16_bf16 v[64:79], v[124:127], a[28:31], v[64:79]
    s_waitcnt vmcnt(10)
    v_mfma_f32_32x32x16_bf16 v[16:31], v[128:131], a[32:35], v[16:31]
    buffer_load_dwordx4 a[80:83], v2, s[4:7], s11 offen offset:3072 sc1
    v_mfma_f32_32x32x16_bf16 v[32:47], v[128:131], a[36:39], v[32:47]
    s_nop 0
    s_cbranch_execz L_walk
    v_mfma_f32_32x32x16_bf16 v[48:63], v[132:135], a[32:35], v[48:63]
    buffer_load_dwordx4 a[84:87], v2, s[4:7], s12 offen offset:3072 sc1
    v_mfma_f32_32x32x16_bf16 v[64:79], v[132:135], a[36:39], v[64:79]
    s_waitcnt vmcnt(10)
    v_mfma_f32_32x32x16_bf16 v[16:31], v[136:139], a[40:43], v[16:31]
    s_add_u32 s11, s11, 4096
    s_add_u32 s12, s12, 4096
    buffer_load_dwordx4 a[88:91], v2, s[4:7], s11 offen offset:0 sc1
    v_mfma_f32_32x32x16_bf16 v[32:47], v[136:139], a[44:47], v[32:47]
    v_mfma_f32_32x32x16_bf16 v[48:63], v[140:143], a[40:43], v[48:63]
    buffer_load_dwordx4 a[92:95], v2, s[4:7], s12 offen offset:0 sc1
    v_mfma_f32_32x32x16_bf16 v[64:79], v[140:143], a[44:47], v[64:79]
    s_waitcnt vmcnt(10)
    v_mfma_f32_32x32x16_bf16 v[16:31], v[144:147], a[48:51], v[16:31]
    buffer_load_dwordx4 a[96:99], v2, s[4:7], s11 offen offset:1024 sc1
    v_mfma_f32_32x32x16_bf16 v[32:47], v[144:147], a[52:55], v[32:47]
    v_mfma_f32_32x32x16_bf16 v[48:63], v[148:151], a[48:51], v[48:63]
    buffer_load_dwordx4 a[100:103], v2, s[4:7], s12 offen offset:1024 sc1
    v_mfma_f32_32x32x16_bf16 v[64:79], v[148:151], a[52:55], v[64:79]
    s_waitcnt vmcnt(10)
    v_mfma_f32_32x32x16_bf16 v[16:31], v[152:155], a[56:59], v[16:31]
    buffer_load_dwordx4 a[104:107], v2, s[4:7], s11 offen offset:2048 sc1
    v_mfma_f32_32x32x16_bf16 v[32:47], v[152:155], a[60:63], v[32:47]
    v_mfma_f32_32x32x16_bf16 v[48:63], v[156:159], a[56:59], v[48:63]
    buffer_load_dwordx4 a[108:111], v2, s[4:7], s12 offen offset:2048 sc1
    v_mfma_f32_32x32x16_bf16 v[64:79], v[156:159], a[60:63], v[64:79]
    s_waitcnt vmcnt(10)
    v_mfma_f32_32x32x16_bf16 v[16:31], v[160:163], a[64:67], v[16:31]
    v_mfma_f32_32x32x16_bf16 v[32:47], v[160:163], a[68:71], v[32:47]
    v_mfma_f32_32x32x16_bf16 v[48:63], v[164:167], a[64:67], v[48:63]
    v_mfma_f32_32x32x16_bf16 v[64:79], v[164:167], a[68:71], v[64:79]
    s_waitcnt vmcnt(8)
    v_mfma_f32_32x32x16_bf16 v[16:31], v[168:171], a[72:75], v[16:31]
    v_mfma_f32_32x32x16_bf16 v[32:47], v[168:171], a[76:79], v[32:47]
    v_mfma_f32_32x32x16_bf16 v[48:63], v[172:175], a[72:75], v[48:63]
    v_mfma_f32_32x32x16_bf16 v[64:79], v[172:175], a[76:79], v[64:79]
    s_waitcnt vmcnt(6)
    v_mfma_f32_32x32x16_bf16 v[32:47], v[176:179], a[84:87], v[32:47]
    s_waitcnt vmcnt(4)
    v_mfma_f32_32x32x16_bf16 v[32:47], v[184:187], a[92:95], v[32:47]
    s_waitcnt vmcnt(2)
    v_mfma_f32_32x32x16_bf16 v[32:47], v[192:195], a[100:103], v[32:47]
    s_waitcnt vmcnt(0)
    v_mfma_f32_32x32x16_bf16 v[32:47], v[200:203], a[108:111], v[32:47]
    s_cmp_lg_u32 s30, 0
    s_cbranch_scc1 L_qd16
    s_mov_b32 m0, s41
    s_add_u32 s41, s41, 4096
    buffer_load_dwordx4 v2, s[4:7], s40 offen sc1 lds
    s_add_u32 s40, s40, 4096
L_qd16:
    s_nop 4
    v_mfma_f32_32x32x16_bf16 v[48:63], v[180:183], a[80:83], v[48:63]
    s_cmp_lg_u32 s30, 0
    s_cbranch_scc1 L_qd17
    s_mov_b32 m0, s41
    s_add_u32 s41, s41, 4096
    buffer_load_dwordx4 v2, s[4:7], s40 offen sc1 lds
    s_add_u32 s40, s40, 4096
L_qd17:
    s_nop 4
    v_mfma_f32_32x32x16_bf16 v[48:63], v[188:191], a[88:91], v[48:63]
    s_cmp_lg_u32 s30, 0
    s_cbranch_scc1 L_qd18
    s_mov_b32 m0, s41
    s_add_u32 s41, s41, 4096
    buffer_load_dwordx4 v2, s[4:7], s40 offen sc1 lds
    s_add_u32 s40, s40, 4096
L_qd18:
    s_nop 4
    v_mfma_f32_32x32x16_bf16 v[48:63], v[196:199], a[96:99], v[48:63]
    ds_write_b128 v9, v[32:35] offset:0
    ds_write_b128 v9, v[36:39] offset:1024
    s_nop 2
    v_mfma_f32_32x32x16_bf16 v[48:63], v[204:207], a[104:107], v[48:63]
    s_cmp_lg_u32 s30, 0
    s_cbranch_scc1 L_qd19
    s_mov_b32 m0, s41
    s_add_u32 s41, s41, 4096
    s_cbranch_execz L_walk
    buffer_load_dwordx4 v2, s[4:7], s40 offen sc1 lds
    s_add_u32 s40, s40, 4096
L_qd19:
    ds_write_b128 v9, v[40:43] offset:2048
    ds_write_b128 v9, v[44:47] offset:3072
    s_nop 2
    v_mfma_f32_32x32x16_bf16 v[64:79], v[180:183], a[84:87], v[64:79]
    s_cmp_lg_u32 s30, 0
    s_cbranch_scc1 L_qd20
    s_mov_b32 m0, s41
    s_add_u32 s41, s41, 4096
    buffer_load_dwordx4 v2, s[4:7], s40 offen sc1 lds
    s_add_u32 s40, s40, 4096
L_qd20:
    s_nop 4
    v_mfma_f32_32x32x16_bf16 v[64:79], v[188:191], a[92:95], v[64:79]
    s_cmp_lg_u32 s30, 0
    s_cbranch_scc1 L_qd21
    s_mov_b32 m0, s41
    s_add_u32 s41, s41, 4096
    buffer_load_dwordx4 v2, s[4:7], s40 offen sc1 lds
    s_add_u32 s40, s40, 4096
L_qd21:
    s_nop 4
    v_mfma_f32_32x32x16_bf16 v[64:79], v[196:199], a[100:103], v[64:79]
    ds_write_b128 v10, v[48:51] offset:0
    ds_write_b128 v10, v[52:55] offset:1024
    s_nop 2
    v_mfma_f32_32x32x16_bf16 v[64:79], v[204:207], a[108:111], v[64:79]
    s_cmp_lg_u32 s30, 0
    s_cbranch_scc1 L_qd22
    s_mov_b32 m0, s41
    s_add_u32 s41, s41, 4096
    buffer_load_dwordx4 v2, s[4:7], s40 offen sc1 lds
    s_add_u32 s40, s40, 4096
L_qd22:
    ds_write_b128 v10, v[56:59] offset:2048
    ds_write_b128 v10, v[60:63] offset:3072
    s_nop 2
    v_mfma_f32_32x32x16_bf16 v[16:31], v[176:179], a[80:83], v[16:31]
    s_cmp_lg_u32 s30, 0
    s_cbranch_scc1 L_qd23
    s_mov_b32 m0, s41
    s_add_u32 s41, s41, 4096
    buffer_load_dwordx4 v2, s[4:7], s40 offen sc1 lds
    s_add_u32 s40, s40, 4096
L_qd23:
    s_nop 4
    v_mfma_f32_32x32x16_bf16 v[16:31], v[184:187], a[88:91], v[16:31]
    s_cmp_lg_u32 s30, 0
    s_cbranch_scc1 L_qd24
    s_mov_b32 m0, s41
    s_add_u32 s41, s41, 4096
    buffer_load_dwordx4 v2, s[4:7], s40 offen sc1 lds
    s_add_u32 s40, s40, 4096
L_qd24:
    s_nop 4
    v_mfma_f32_32x32x16_bf16 v[16:31], v[192:195], a[96:99], v[16:31]
    ds_write_b128 v11, v[64:67] offset:0
    ds_write_b128 v11, v[68:71] offset:1024
    s_nop 2
    v_mfma_f32_32x32x16_bf16 v[16:31], v[200:203], a[104:107], v[16:31]
    ds_write_b128 v11, v[72:75] offset:2048
    ds_write_b128 v11, v[76:79] offset:3072
    s_nop 2
    s_add_u32 s14, s66, 3145728
    s_add_u32 s19, s67, 6815744
    s_cmp_lg_u32 s30, 0
    s_cbranch_scc1 L_qd25
    s_mov_b32 m0, s41
    s_add_u32 s41, s41, 4096
    buffer_load_dwordx4 v2, s[4:7], s40 offen sc1 lds
    s_add_u32 s40, s40, 4096
L_qd25:
    s_waitcnt lgkmcnt(0)
    s_barrier
    ds_read_b128 v[32:35], v8 offset:0
    ds_read_b128 v[36:39], v8 offset:1024
    ds_read_b128 v[40:43], v8 offset:2048
    ds_read_b128 v[44:47], v8 offset:3072
    ds_read_b128 v[48:51], v8 offset:4096
    ds_read_b128 v[52:55], v8 offset:5120
    ds_read_b128 v[56:59], v8 offset:6144
    ds_read_b128 v[60:63], v8 offset:7168
    ds_read_b128 v[64:67], v8 offset:8192
    s_cbranch_execz L_walk
    ds_read_b128 v[68:71], v8 offset:9216
    ds_read_b128 v[72:75], v8 offset:10240
    ds_read_b128 v[76:79], v8 offset:11264
    s_cmp_lg_u32 s30, 0
    s_cbranch_scc1 L_qd26
    s_mov_b32 m0, s41
    s_add_u32 s41, s41, 4096
    buffer_load_dwordx4 v2, s[4:7], s40 offen sc1 lds
    s_add_u32 s40, s40, 4096
L_qd26:
    s_cmp_lg_u32 s30, 0
    s_cbranch_scc1 L_qd27
    s_mov_b32 m0, s41
    s_add_u32 s41, s41, 4096
    buffer_load_dwordx4 v2, s[4:7], s40 offen sc1 lds
    s_add_u32 s40, s40, 4096
L_qd27:
    s_waitcnt lgkmcnt(8)
    v_pk_add_f32 v[240:241], v[16:17], v[32:33]
    v_pk_add_f32 v[242:243], v[18:19], v[34:35]
    v_pk_add_f32 v[244:245], v[20:21], v[36:37]
    v_pk_add_f32 v[246:247], v[22:23], v[38:39]
    v_pk_add_f32 v[248:249], v[24:25], v[40:41]
    v_pk_add_f32 v[250:251], v[26:27], v[42:43]
    v_pk_add_f32 v[252:253], v[28:29], v[44:45]
    v_pk_add_f32 v[254:255], v[30:31], v[46:47]
    s_cmp_lg_u32 s30, 0
    s_cbranch_scc1 L_qd28
    s_mov_b32 m0, s41
    s_add_u32 s41, s41, 4096
    buffer_load_dwordx4 v2, s[4:7], s40 offen sc1 lds
    s_add_u32 s40, s40, 4096
L_qd28:
    s_waitcnt lgkmcnt(4)
    v_pk_add_f32 v[240:241], v[240:241], v[48:49]
    v_pk_add_f32 v[242:243], v[242:243], v[50:51]
    v_pk_add_f32 v[244:245], v[244:245], v[52:53]
    v_pk_add_f32 v[246:247], v[246:247], v[54:55]
    v_pk_add_f32 v[248:249], v[248:249], v[56:57]
    v_pk_add_f32 v[250:251], v[250:251], v[58:59]
    v_pk_add_f32 v[252:253], v[252:253], v[60:61]
    v_pk_add_f32 v[254:255], v[254:255], v[62:63]
    s_cmp_lg_u32 s30, 0
    s_cbranch_scc1 L_qd29
    s_mov_b32 m0, s41
    s_add_u32 s41, s41, 4096
    buffer_load_dwordx4 v2, s[4:7], s40 offen sc1 lds
    s_add_u32 s40, s40, 4096
L_qd29:
    s_waitcnt lgkmcnt(0)
    v_pk_add_f32 v[240:241], v[240:241], v[64:65]
    v_pk_add_f32 v[242:243], v[242:243], v[66:67]
    v_pk_add_f32 v[244:245], v[244:245], v[68:69]
    v_pk_add_f32 v[246:247], v[246:247], v[70:71]
    v_pk_add_f32 v[248:249], v[248:249], v[72:73]
    v_pk_add_f32 v[250:251], v[250:251], v[74:75]
    v_pk_add_f32 v[252:253], v[252:253], v[76:77]
    v_pk_add_f32 v[254:255], v[254:255], v[78:79]
    v_cvt_pk_bf16_f32 v80, v240, v241
    v_cvt_pk_bf16_f32 v81, v242, v243
    v_cvt_pk_bf16_f32 v82, v244, v245
    v_cvt_pk_bf16_f32 v83, v246, v247
    v_cvt_pk_bf16_f32 v84, v248, v249
    v_cvt_pk_bf16_f32 v85, v250, v251
    v_cvt_pk_bf16_f32 v86, v252, v253
    v_cvt_pk_bf16_f32 v87, v254, v255
    s_cmp_eq_u32 s30, 1
    s_cbranch_scc1 L_final
    s_cmp_lg_u32 s35, 0
    s_cbranch_scc1 L_hs30
    buffer_store_dwordx4 v[80:83], v2, s[4:7], s14 offen
    buffer_store_dwordx4 v[84:87], v2, s[4:7], s14 offen offset:1024
L_hb30:
    v_pk_add_f32 v[88:89], v[240:241], v[242:243]
    v_pk_mul_f32 v[90:91], v[240:241], v[240:241]
    v_pk_fma_f32 v[90:91], v[242:243], v[242:243], v[90:91]
    v_pk_add_f32 v[88:89], v[88:89], v[244:245]
    v_pk_fma_f32 v[90:91], v[244:245], v[244:245], v[90:91]
    s_cbranch_execz L_walk
    v_pk_add_f32 v[88:89], v[88:89], v[246:247]
    v_pk_fma_f32 v[90:91], v[246:247], v[246:247], v[90:91]
    v_pk_add_f32 v[88:89], v[88:89], v[248:249]
    v_pk_fma_f32 v[90:91], v[248:249], v[248:249], v[90:91]
    v_pk_add_f32 v[88:89], v[88:89], v[250:251]
    v_pk_fma_f32 v[90:91], v[250:251], v[250:251], v[90:91]
    v_pk_add_f32 v[88:89], v[88:89], v[252:253]
    v_pk_fma_f32 v[90:91], v[252:253], v[252:253], v[90:91]
    v_pk_add_f32 v[88:89], v[88:89], v[254:255]
    v_pk_fma_f32 v[90:91], v[254:255], v[254:255], v[90:91]
    v_add_f32 v88, v88, v89
    v_add_f32 v90, v90, v91
    s_nop 1
    v_permlane32_swap_b32 v88, v90
    v_add_f32 v88, v88, v90
    s_cmp_lg_u32 s35, 0
    s_cbranch_scc1 L_hs31
    buffer_store_dword v88, v4, s[4:7], s19 offen
L_hb31:
    s_waitcnt vmcnt(0)
    s_add_u32 s24, s32, s18
    s_mov_b64 exec, 1
    s_cmp_lg_u32 s35, 0
    s_cbranch_scc1 L_hs32
    buffer_store_dwordx2 v[214:215], off, s[4:7], s24 offset:2048
L_hb32:
    s_mov_b64 exec, -1
L_next:
    v_and_b32 v12, 15, v1
    v_lshlrev_b32 v12, 7, v12
    v_add_u32 v13, s65, v12
    s_mov_b32 vcc_lo, 0xffff
    s_mov_b32 vcc_hi, 0
    v_cndmask_b32 v210, v210, v13, vcc
    s_add_u32 s12, s66, 3145728
    v_add_u32 v13, s12, v12
    s_mov_b32 vcc_lo, 0xffff0000
    v_cndmask_b32 v210, v210, v13, vcc
    s_add_u32 s12, s67, 6815744
    v_add_u32 v13, s12, v12
    s_mov_b32 vcc_lo, 0
    s_mov_b32 vcc_hi, 3
    v_cndmask_b32 v210, v210, v13, vcc
    buffer_load_dwordx2 v[14:15], v0, s[4:7], s1 offen offset:2048 sc1
    s_waitcnt vmcnt(0)
    v_cmp_ne_u64 vcc, s[42:43], v[14:15]
    s_cbranch_vccnz L_pl33
L_pb33:
    s_mov_b32 s30, 1
    s_mov_b32 s31, 20971520
    s_add_u32 s32, s32, 0x10000
    s_add_u32 s1, s1, 0x10000
    s_branch L_qkv1
L_idle:
    s_cmp_eq_u32 s30, 1
    s_cbranch_scc1 L_end
    s_lshl_b32 s41, s3, 10
    s_add_u32 s40, s41, s77
    s_mov_b32 m0, s41
    s_add_u32 s41, s41, 4096
    buffer_load_dwordx4 v2, s[4:7], s40 offen sc1 lds
    s_add_u32 s40, s40, 4096
    s_mov_b32 m0, s41
    s_add_u32 s41, s41, 4096
    buffer_load_dwordx4 v2, s[4:7], s40 offen sc1 lds
    s_add_u32 s40, s40, 4096
    s_mov_b32 m0, s41
    s_add_u32 s41, s41, 4096
    buffer_load_dwordx4 v2, s[4:7], s40 offen sc1 lds
    s_add_u32 s40, s40, 4096
    s_mov_b32 m0, s41
    s_add_u32 s41, s41, 4096
    buffer_load_dwordx4 v2, s[4:7], s40 offen sc1 lds
    s_add_u32 s40, s40, 4096
    s_mov_b32 m0, s41
    s_add_u32 s41, s41, 4096
    buffer_load_dwordx4 v2, s[4:7], s40 offen sc1 lds
    s_add_u32 s40, s40, 4096
    s_mov_b32 m0, s41
    s_add_u32 s41, s41, 4096
    buffer_load_dwordx4 v2, s[4:7], s40 offen sc1 lds
    s_add_u32 s40, s40, 4096
    s_mov_b32 m0, s41
    s_add_u32 s41, s41, 4096
    buffer_load_dwordx4 v2, s[4:7], s40 offen sc1 lds
    s_add_u32 s40, s40, 4096
    s_mov_b32 m0, s41
    s_add_u32 s41, s41, 4096
    buffer_load_dwordx4 v2, s[4:7], s40 offen sc1 lds
    s_cbranch_execz L_walk
    s_add_u32 s40, s40, 4096
    s_mov_b32 m0, s41
    s_add_u32 s41, s41, 4096
    buffer_load_dwordx4 v2, s[4:7], s40 offen sc1 lds
    s_add_u32 s40, s40, 4096
    s_mov_b32 m0, s41
    s_add_u32 s41, s41, 4096
    buffer_load_dwordx4 v2, s[4:7], s40 offen sc1 lds
    s_add_u32 s40, s40, 4096
    s_mov_b32 m0, s41
    s_add_u32 s41, s41, 4096
    buffer_load_dwordx4 v2, s[4:7], s40 offen sc1 lds
    s_add_u32 s40, s40, 4096
    s_mov_b32 m0, s41
    s_add_u32 s41, s41, 4096
    buffer_load_dwordx4 v2, s[4:7], s40 offen sc1 lds
    s_add_u32 s40, s40, 4096
    s_mov_b32 m0, s41
    s_add_u32 s41, s41, 4096
    buffer_load_dwordx4 v2, s[4:7], s40 offen sc1 lds
    s_add_u32 s40, s40, 4096
    s_mov_b32 m0, s41
    s_add_u32 s41, s41, 4096
    buffer_load_dwordx4 v2, s[4:7], s40 offen sc1 lds
    s_add_u32 s40, s40, 4096
    s_branch L_next
L_cs1:
    s_lshr_b32 s16, s3, 1
    s_mul_i32 s16, s16, 57344
    s_and_b32 s19, s3, 1
    s_lshl_b32 s19, s19, 9
    s_add_u32 s16, s16, s19
    v_add_u32 v13, s16, v213
    v_mov_b32 v14, 0
    v_mov_b32 v15, 0
    v_mov_b32 v12, 0x3f803f80
    ds_read_b64_tr_b16 v[112:113], v13 offset:0
    ds_read_b64_tr_b16 v[114:115], v13 offset:1024
    ds_read_b64_tr_b16 v[116:117], v13 offset:2048
    ds_read_b64_tr_b16 v[118:119], v13 offset:3072
    ds_read_b64_tr_b16 v[120:121], v13 offset:4096
    ds_read_b64_tr_b16 v[122:123], v13 offset:5120
    ds_read_b64_tr_b16 v[124:125], v13 offset:6144
    ds_read_b64_tr_b16 v[126:127], v13 offset:7168
    ds_read_b64_tr_b16 v[128:129], v13 offset:8192
    ds_read_b64_tr_b16 v[130:131], v13 offset:9216
    ds_read_b64_tr_b16 v[132:133], v13 offset:10240
    ds_read_b64_tr_b16 v[134:135], v13 offset:11264
    ds_read_b64_tr_b16 v[136:137], v13 offset:12288
    ds_read_b64_tr_b16 v[138:139], v13 offset:13312
    s_waitcnt lgkmcnt(12)
    v_dot2c_f32_bf16 v14, v112, v12
    v_dot2c_f32_bf16 v15, v113, v12
    v_dot2c_f32_bf16 v14, v114, v12
    v_dot2c_f32_bf16 v15, v115, v12
    ds_read_b64_tr_b16 v[140:141], v13 offset:14336
    ds_read_b64_tr_b16 v[142:143], v13 offset:15360
    s_waitcnt lgkmcnt(12)
    v_dot2c_f32_bf16 v14, v116, v12
    v_dot2c_f32_bf16 v15, v117, v12
    v_dot2c_f32_bf16 v14, v118, v12
    v_dot2c_f32_bf16 v15, v119, v12
    ds_read_b64_tr_b16 v[112:113], v13 offset:16384
    ds_read_b64_tr_b16 v[114:115], v13 offset:17408
    s_waitcnt lgkmcnt(12)
    v_dot2c_f32_bf16 v14, v120, v12
    v_dot2c_f32_bf16 v15, v121, v12
    v_dot2c_f32_bf16 v14, v122, v12
    v_dot2c_f32_bf16 v15, v123, v12
    ds_read_b64_tr_b16 v[116:117], v13 offset:18432
    ds_read_b64_tr_b16 v[118:119], v13 offset:19456
    s_waitcnt lgkmcnt(12)
    v_dot2c_f32_bf16 v14, v124, v12
    v_dot2c_f32_bf16 v15, v125, v12
    v_dot2c_f32_bf16 v14, v126, v12
    v_dot2c_f32_bf16 v15, v127, v12
    ds_read_b64_tr_b16 v[120:121], v13 offset:20480
    ds_read_b64_tr_b16 v[122:123], v13 offset:21504
    s_waitcnt lgkmcnt(12)
    v_dot2c_f32_bf16 v14, v128, v12
    v_dot2c_f32_bf16 v15, v129, v12
    v_dot2c_f32_bf16 v14, v130, v12
    v_dot2c_f32_bf16 v15, v131, v12
    ds_read_b64_tr_b16 v[124:125], v13 offset:22528
    s_cbranch_execz L_walk
    ds_read_b64_tr_b16 v[126:127], v13 offset:23552
    s_waitcnt lgkmcnt(12)
    v_dot2c_f32_bf16 v14, v132, v12
    v_dot2c_f32_bf16 v15, v133, v12
    v_dot2c_f32_bf16 v14, v134, v12
    v_dot2c_f32_bf16 v15, v135, v12
    ds_read_b64_tr_b16 v[128:129], v13 offset:24576
    ds_read_b64_tr_b16 v[130:131], v13 offset:25600
    s_waitcnt lgkmcnt(12)
    v_dot2c_f32_bf16 v14, v136, v12
    v_dot2c_f32_bf16 v15, v137, v12
    v_dot2c_f32_bf16 v14, v138, v12
    v_dot2c_f32_bf16 v15, v139, v12
    s_branch L_cs1b
L_cs2:
    v_permlane32_swap_b32 v104, v106
    v_permlane32_swap_b32 v105, v107
    v_permlane32_swap_b32 v108, v110
    v_permlane32_swap_b32 v109, v111
    v_lshlrev_b32 v240, 16, v104
    v_and_b32 v241, 0xffff0000, v104
    v_lshlrev_b32 v242, 16, v105
    v_and_b32 v243, 0xffff0000, v105
    v_lshlrev_b32 v244, 16, v106
    v_and_b32 v245, 0xffff0000, v106
    v_lshlrev_b32 v246, 16, v107
    v_and_b32 v247, 0xffff0000, v107
    v_lshlrev_b32 v248, 16, v108
    v_and_b32 v249, 0xffff0000, v108
    v_lshlrev_b32 v250, 16, v109
    v_and_b32 v251, 0xffff0000, v109
    v_lshlrev_b32 v252, 16, v110
    v_and_b32 v253, 0xffff0000, v110
    v_lshlrev_b32 v254, 16, v111
    v_and_b32 v255, 0xffff0000, v111
    ds_read_b64_tr_b16 v[132:133], v13 offset:26624
    ds_read_b64_tr_b16 v[134:135], v13 offset:27648
    s_waitcnt lgkmcnt(12)
    v_dot2c_f32_bf16 v14, v140, v12
    v_dot2c_f32_bf16 v15, v141, v12
    v_dot2c_f32_bf16 v14, v142, v12
    v_dot2c_f32_bf16 v15, v143, v12
    ds_read_b64_tr_b16 v[136:137], v13 offset:28672
    ds_read_b64_tr_b16 v[138:139], v13 offset:29696
    s_waitcnt lgkmcnt(12)
    v_dot2c_f32_bf16 v14, v112, v12
    v_dot2c_f32_bf16 v15, v113, v12
    v_dot2c_f32_bf16 v14, v114, v12
    v_dot2c_f32_bf16 v15, v115, v12
    ds_read_b64_tr_b16 v[140:141], v13 offset:30720
    ds_read_b64_tr_b16 v[142:143], v13 offset:31744
    s_waitcnt lgkmcnt(12)
    v_dot2c_f32_bf16 v14, v116, v12
    v_dot2c_f32_bf16 v15, v117, v12
    v_dot2c_f32_bf16 v14, v118, v12
    v_dot2c_f32_bf16 v15, v119, v12
    ds_read_b64_tr_b16 v[112:113], v13 offset:32768
    ds_read_b64_tr_b16 v[114:115], v13 offset:33792
    s_waitcnt lgkmcnt(12)
    v_dot2c_f32_bf16 v14, v120, v12
    v_dot2c_f32_bf16 v15, v121, v12
    v_dot2c_f32_bf16 v14, v122, v12
    v_dot2c_f32_bf16 v15, v123, v12
    ds_read_b64_tr_b16 v[116:117], v13 offset:34816
    ds_read_b64_tr_b16 v[118:119], v13 offset:35840
    s_waitcnt lgkmcnt(12)
    v_dot2c_f32_bf16 v14, v124, v12
    v_dot2c_f32_bf16 v15, v125, v12
    v_dot2c_f32_bf16 v14, v126, v12
    v_dot2c_f32_bf16 v15, v127, v12
    ds_read_b64_tr_b16 v[120:121], v13 offset:36864
    ds_read_b64_tr_b16 v[122:123], v13 offset:37888
    s_waitcnt lgkmcnt(12)
    v_dot2c_f32_bf16 v14, v128, v12
    v_dot2c_f32_bf16 v15, v129, v12
    v_dot2c_f32_bf16 v14, v130, v12
    v_dot2c_f32_bf16 v15, v131, v12
    ds_read_b64_tr_b16 v[124:125], v13 offset:38912
    ds_read_b64_tr_b16 v[126:127], v13 offset:39936
    s_waitcnt lgkmcnt(12)
    v_dot2c_f32_bf16 v14, v132, v12
    v_dot2c_f32_bf16 v15, v133, v12
    v_dot2c_f32_bf16 v14, v134, v12
    v_dot2c_f32_bf16 v15, v135, v12
    ds_read_b64_tr_b16 v[128:129], v13 offset:40960
    ds_read_b64_tr_b16 v[130:131], v13 offset:41984
    s_waitcnt lgkmcnt(12)
    v_dot2c_f32_bf16 v14, v136, v12
    v_dot2c_f32_bf16 v15, v137, v12
    v_dot2c_f32_bf16 v14, v138, v12
    v_dot2c_f32_bf16 v15, v139, v12
    ds_read_b64_tr_b16 v[132:133], v13 offset:43008
    ds_read_b64_tr_b16 v[134:135], v13 offset:44032
    s_waitcnt lgkmcnt(12)
    v_dot2c_f32_bf16 v14, v140, v12
    v_dot2c_f32_bf16 v15, v141, v12
    v_dot2c_f32_bf16 v14, v142, v12
    v_dot2c_f32_bf16 v15, v143, v12
    s_nop 0
    s_cbranch_execz L_walk
    ds_read_b64_tr_b16 v[136:137], v13 offset:45056
    ds_read_b64_tr_b16 v[138:139], v13 offset:46080
    s_waitcnt lgkmcnt(12)
    v_dot2c_f32_bf16 v14, v112, v12
    v_dot2c_f32_bf16 v15, v113, v12
    v_dot2c_f32_bf16 v14, v114, v12
    v_dot2c_f32_bf16 v15, v115, v12
    ds_read_b64_tr_b16 v[140:141], v13 offset:47104
    ds_read_b64_tr_b16 v[142:143], v13 offset:48128
    s_waitcnt lgkmcnt(12)
    v_dot2c_f32_bf16 v14, v116, v12
    v_dot2c_f32_bf16 v15, v117, v12
    v_dot2c_f32_bf16 v14, v118, v12
    v_dot2c_f32_bf16 v15, v119, v12
    ds_read_b64_tr_b16 v[112:113], v13 offset:49152
    ds_read_b64_tr_b16 v[114:115], v13 offset:50176
    s_waitcnt lgkmcnt(12)
    v_dot2c_f32_bf16 v14, v120, v12
    v_dot2c_f32_bf16 v15, v121, v12
    v_dot2c_f32_bf16 v14, v122, v12
    v_dot2c_f32_bf16 v15, v123, v12
    ds_read_b64_tr_b16 v[116:117], v13 offset:51200
    ds_read_b64_tr_b16 v[118:119], v13 offset:52224
    s_waitcnt lgkmcnt(12)
    v_dot2c_f32_bf16 v14, v124, v12
    v_dot2c_f32_bf16 v15, v125, v12
    v_dot2c_f32_bf16 v14, v126, v12
    v_dot2c_f32_bf16 v15, v127, v12
    ds_read_b64_tr_b16 v[120:121], v13 offset:53248
    ds_read_b64_tr_b16 v[122:123], v13 offset:54272
    s_waitcnt lgkmcnt(12)
    v_dot2c_f32_bf16 v14, v128, v12
    v_dot2c_f32_bf16 v15, v129, v12
    v_dot2c_f32_bf16 v14, v130, v12
    v_dot2c_f32_bf16 v15, v131, v12
    ds_read_b64_tr_b16 v[124:125], v13 offset:55296
    ds_read_b64_tr_b16 v[126:127], v13 offset:56320
    s_waitcnt lgkmcnt(12)
    v_dot2c_f32_bf16 v14, v132, v12
    v_dot2c_f32_bf16 v15, v133, v12
    v_dot2c_f32_bf16 v14, v134, v12
    v_dot2c_f32_bf16 v15, v135, v12
    s_waitcnt lgkmcnt(10)
    v_dot2c_f32_bf16 v14, v136, v12
    v_dot2c_f32_bf16 v15, v137, v12
    v_dot2c_f32_bf16 v14, v138, v12
    v_dot2c_f32_bf16 v15, v139, v12
    s_waitcnt lgkmcnt(8)
    v_dot2c_f32_bf16 v14, v140, v12
    v_dot2c_f32_bf16 v15, v141, v12
    v_dot2c_f32_bf16 v14, v142, v12
    v_dot2c_f32_bf16 v15, v143, v12
    s_waitcnt lgkmcnt(6)
    v_dot2c_f32_bf16 v14, v112, v12
    v_dot2c_f32_bf16 v15, v113, v12
    v_dot2c_f32_bf16 v14, v114, v12
    v_dot2c_f32_bf16 v15, v115, v12
    s_waitcnt lgkmcnt(4)
    v_dot2c_f32_bf16 v14, v116, v12
    v_dot2c_f32_bf16 v15, v117, v12
    v_dot2c_f32_bf16 v14, v118, v12
    v_dot2c_f32_bf16 v15, v119, v12
    s_waitcnt lgkmcnt(2)
    v_dot2c_f32_bf16 v14, v120, v12
    v_dot2c_f32_bf16 v15, v121, v12
    v_dot2c_f32_bf16 v14, v122, v12
    v_dot2c_f32_bf16 v15, v123, v12
    s_waitcnt lgkmcnt(0)
    v_dot2c_f32_bf16 v14, v124, v12
    v_dot2c_f32_bf16 v15, v125, v12
    v_dot2c_f32_bf16 v14, v126, v12
    v_dot2c_f32_bf16 v15, v127, v12
    s_lshl_b32 s16, s2, 11
    s_lshl_b32 s19, s3, 9
    s_add_u32 s16, s16, s19
    s_add_u32 s16, s16, 2097152
    v_add_f32 v14, v14, v15
    v_mov_b32 v15, v14
    v_lshlrev_b32 v13, 3, v1
    s_nop 0
    v_permlane32_swap_b32 v14, v15
    v_add_f32 v14, v14, v15
    v_cvt_pk_bf16_f32 v15, v14, v14
    v_and_b32 v15, 0xffff0000, v15
    v_sub_f32 v15, v14, v15
    v_cvt_pk_bf16_f32 v112, v14, v15
    v_mov_b32 v113, v112
    buffer_store_dwordx2 v[112:113], v13, s[4:7], s16 offen sc1
    s_branch L_cs2b
L_tail0:
    s_mov_b32 s36, s48
    s_mov_b32 s37, s49
    s_mov_b32 s38, 1835008
    s_mov_b32 s39, 0x20000
    v_and_b32 v86, 31, v1
    v_mul_u32_u24 v86, 896, v86
    v_lshl_add_u32 v86, v5, 4, v86
    s_lshr_b32 s24, s67, 12
    s_mul_i32 s24, s24, 28672
    s_and_b32 s25, s67, 0xf00
    s_lshr_b32 s25, s25, 2
    s_add_u32 s24, s24, s25
    v_mfma_f32_32x32x16_bf16 v[128:143], a[0:3], v[24:27], 0
    s_nop 0
    s_cbranch_execz L_walk
    s_xor_b32 s11, s26, 147456
    v_exp_f32 v112, v112
    v_exp_f32 v113, v113
    v_exp_f32 v114, v114
    v_exp_f32 v115, v115
    v_cvt_pk_bf16_f32 v144, v112, v113
    v_exp_f32 v116, v116
    v_mfma_f32_32x32x16_bf16 v[128:143], a[4:7], v[28:31], v[128:143]
    buffer_load_dwordx4 a[48:51], v2, s[44:47], s11 offen offset:0 sc1
    v_exp_f32 v117, v117
    v_cvt_pk_bf16_f32 v145, v114, v115
    v_exp_f32 v118, v118
    v_exp_f32 v119, v119
    v_cvt_pk_bf16_f32 v146, v116, v117
    v_exp_f32 v120, v120
    v_mfma_f32_32x32x16_bf16 v[48:63], a[56:59], v[152:155], v[48:63]
    buffer_load_dwordx4 v[104:107], v86, s[36:39], s24 offen
    v_exp_f32 v121, v121
    v_cvt_pk_bf16_f32 v147, v118, v119
    v_exp_f32 v122, v122
    v_exp_f32 v123, v123
    v_cvt_pk_bf16_f32 v148, v120, v121
    v_exp_f32 v124, v124
    v_mfma_f32_32x32x16_bf16 v[48:63], a[60:63], v[156:159], v[48:63]
    buffer_load_dwordx4 a[52:55], v2, s[44:47], s11 offen offset:1024 sc1
    v_exp_f32 v125, v125
    v_exp_f32 v126, v126
    v_cvt_pk_bf16_f32 v149, v122, v123
    v_exp_f32 v127, v127
    v_cvt_pk_bf16_f32 v150, v124, v125
    v_cvt_pk_bf16_f32 v151, v126, v127
    v_mfma_f32_32x32x16_bf16 v[112:127], a[0:3], v[32:35], 0
    buffer_load_dwordx4 v[108:111], v86, s[36:39], s24 offen offset:32
    v_exp_f32 v128, v128
    v_exp_f32 v129, v129
    v_exp_f32 v130, v130
    v_exp_f32 v131, v131
    v_cvt_pk_bf16_f32 v152, v128, v129
    v_exp_f32 v132, v132
    v_mfma_f32_32x32x16_bf16 v[112:127], a[4:7], v[36:39], v[112:127]
    buffer_load_dwordx4 a[56:59], v2, s[44:47], s11 offen offset:2048 sc1
    v_exp_f32 v133, v133
    v_cvt_pk_bf16_f32 v153, v130, v131
    v_exp_f32 v134, v134
    v_exp_f32 v135, v135
    v_cvt_pk_bf16_f32 v154, v132, v133
    v_exp_f32 v136, v136
    v_mfma_f32_32x32x16_bf16 v[160:175], a[8:11], v[144:147], v[160:175]
    s_waitcnt vmcnt(5)
    v_cmp_ne_u64 vcc, s[42:43], v[14:15]
    s_cbranch_vccnz L_pl48
    v_cmp_ne_u64 vcc, s[42:43], v[12:13]
    s_cbranch_vccnz L_pl48
L_pb48:
    v_exp_f32 v137, v137
    v_cvt_pk_bf16_f32 v155, v134, v135
    v_exp_f32 v138, v138
    v_exp_f32 v139, v139
    v_cvt_pk_bf16_f32 v156, v136, v137
    v_exp_f32 v140, v140
    v_mfma_f32_32x32x16_bf16 v[160:175], a[12:15], v[148:151], v[160:175]
    buffer_load_dwordx4 a[60:63], v2, s[44:47], s11 offen offset:3072 sc1
    v_exp_f32 v141, v141
    v_exp_f32 v142, v142
    v_cvt_pk_bf16_f32 v157, v138, v139
    v_exp_f32 v143, v143
    v_cvt_pk_bf16_f32 v158, v140, v141
    v_cvt_pk_bf16_f32 v159, v142, v143
    v_mfma_f32_32x32x16_bf16 v[128:143], a[0:3], v[40:43], 0
    buffer_load_dwordx4 a[64:67], v6, s[4:7], s13 offen offset:0 sc1
    v_exp_f32 v112, v112
    v_exp_f32 v113, v113
    v_exp_f32 v114, v114
    v_exp_f32 v115, v115
    v_cvt_pk_bf16_f32 v144, v112, v113
    v_exp_f32 v116, v116
    v_mfma_f32_32x32x16_bf16 v[128:143], a[4:7], v[44:47], v[128:143]
    buffer_load_dwordx4 a[68:71], v7, s[4:7], s13 offen offset:0 sc1
    v_exp_f32 v117, v117
    v_cvt_pk_bf16_f32 v145, v114, v115
    v_exp_f32 v118, v118
    v_exp_f32 v119, v119
    v_cvt_pk_bf16_f32 v146, v116, v117
    v_exp_f32 v120, v120
    v_mfma_f32_32x32x16_bf16 v[176:191], a[8:11], v[152:155], v[176:191]
    buffer_load_dwordx4 a[72:75], v6, s[4:7], s13 offen offset:2048 sc1
    v_exp_f32 v121, v121
    v_cvt_pk_bf16_f32 v147, v118, v119
    s_cbranch_execz L_walk
    v_exp_f32 v122, v122
    v_exp_f32 v123, v123
    v_cvt_pk_bf16_f32 v148, v120, v121
    v_exp_f32 v124, v124
    v_mfma_f32_32x32x16_bf16 v[176:191], a[12:15], v[156:159], v[176:191]
    s_waitcnt vmcnt(21)
    v_exp_f32 v125, v125
    v_exp_f32 v126, v126
    v_cvt_pk_bf16_f32 v149, v122, v123
    v_exp_f32 v127, v127
    v_cvt_pk_bf16_f32 v150, v124, v125
    v_cvt_pk_bf16_f32 v151, v126, v127
    v_mfma_f32_32x32x16_bf16 v[112:127], a[16:19], v[16:19], 0
    buffer_load_dwordx4 a[76:79], v7, s[4:7], s13 offen offset:2048 sc1
    v_exp_f32 v128, v128
    v_exp_f32 v129, v129
    v_exp_f32 v130, v130
    v_exp_f32 v131, v131
    v_cvt_pk_bf16_f32 v152, v128, v129
    v_exp_f32 v132, v132
    v_mfma_f32_32x32x16_bf16 v[112:127], a[20:23], v[20:23], v[112:127]
    s_add_u32 s13, s13, 4096
    v_exp_f32 v133, v133
    v_cvt_pk_bf16_f32 v153, v130, v131
    v_exp_f32 v134, v134
    v_exp_f32 v135, v135
    v_cvt_pk_bf16_f32 v154, v132, v133
    v_exp_f32 v136, v136
    v_mfma_f32_32x32x16_bf16 v[192:207], a[8:11], v[144:147], v[192:207]
    buffer_load_dwordx4 a[80:83], v6, s[4:7], s13 offen offset:0 sc1
    v_exp_f32 v137, v137
    v_cvt_pk_bf16_f32 v155, v134, v135
    v_exp_f32 v138, v138
    v_exp_f32 v139, v139
    v_cvt_pk_bf16_f32 v156, v136, v137
    v_exp_f32 v140, v140
    v_mfma_f32_32x32x16_bf16 v[192:207], a[12:15], v[148:151], v[192:207]
    buffer_load_dwordx4 a[84:87], v7, s[4:7], s13 offen offset:0 sc1
    v_exp_f32 v141, v141
    v_exp_f32 v142, v142
    v_cvt_pk_bf16_f32 v157, v138, v139
    v_exp_f32 v143, v143
    v_cvt_pk_bf16_f32 v158, v140, v141
    v_cvt_pk_bf16_f32 v159, v142, v143
    v_mfma_f32_32x32x16_bf16 v[128:143], a[16:19], v[24:27], 0
    buffer_load_dwordx4 a[88:91], v6, s[4:7], s13 offen offset:2048 sc1
    v_exp_f32 v112, v112
    v_exp_f32 v113, v113
    v_exp_f32 v114, v114
    v_exp_f32 v115, v115
    v_cvt_pk_bf16_f32 v144, v112, v113
    v_exp_f32 v116, v116
    v_mfma_f32_32x32x16_bf16 v[128:143], a[20:23], v[28:31], v[128:143]
    buffer_load_dwordx4 a[92:95], v7, s[4:7], s13 offen offset:2048 sc1
    v_exp_f32 v117, v117
    v_cvt_pk_bf16_f32 v145, v114, v115
    v_exp_f32 v118, v118
    v_exp_f32 v119, v119
    v_cvt_pk_bf16_f32 v146, v116, v117
    v_exp_f32 v120, v120
    v_mfma_f32_32x32x16_bf16 v[48:63], a[8:11], v[152:155], v[48:63]
    s_add_u32 s13, s13, 4096
    v_exp_f32 v121, v121
    v_cvt_pk_bf16_f32 v147, v118, v119
    v_exp_f32 v122, v122
    v_exp_f32 v123, v123
    v_cvt_pk_bf16_f32 v148, v120, v121
    v_exp_f32 v124, v124
    v_mfma_f32_32x32x16_bf16 v[48:63], a[12:15], v[156:159], v[48:63]
    buffer_load_dwordx4 a[96:99], v6, s[4:7], s13 offen offset:0 sc1
    v_exp_f32 v125, v125
    v_exp_f32 v126, v126
    v_cvt_pk_bf16_f32 v149, v122, v123
    v_exp_f32 v127, v127
    v_cvt_pk_bf16_f32 v150, v124, v125
    v_cvt_pk_bf16_f32 v151, v126, v127
    v_mfma_f32_32x32x16_bf16 v[112:127], a[16:19], v[32:35], 0
    buffer_load_dwordx4 a[100:103], v7, s[4:7], s13 offen offset:0 sc1
    v_exp_f32 v128, v128
    v_exp_f32 v129, v129
    v_exp_f32 v130, v130
    v_exp_f32 v131, v131
    v_cvt_pk_bf16_f32 v152, v128, v129
    v_exp_f32 v132, v132
    v_mfma_f32_32x32x16_bf16 v[112:127], a[20:23], v[36:39], v[112:127]
    s_nop 0
    s_cbranch_execz L_walk
    buffer_load_dwordx4 a[104:107], v6, s[4:7], s13 offen offset:2048 sc1
    v_exp_f32 v133, v133
    v_cvt_pk_bf16_f32 v153, v130, v131
    v_exp_f32 v134, v134
    v_exp_f32 v135, v135
    v_cvt_pk_bf16_f32 v154, v132, v133
    v_exp_f32 v136, v136
    v_mfma_f32_32x32x16_bf16 v[160:175], a[24:27], v[144:147], v[160:175]
    buffer_load_dwordx4 a[108:111], v7, s[4:7], s13 offen offset:2048 sc1
    v_exp_f32 v137, v137
    v_cvt_pk_bf16_f32 v155, v134, v135
    v_exp_f32 v138, v138
    v_exp_f32 v139, v139
    v_cvt_pk_bf16_f32 v156, v136, v137
    v_exp_f32 v140, v140
    v_mfma_f32_32x32x16_bf16 v[160:175], a[28:31], v[148:151], v[160:175]
    s_add_u32 s13, s13, 4096
    v_exp_f32 v141, v141
    v_exp_f32 v142, v142
    v_cvt_pk_bf16_f32 v157, v138, v139
    v_exp_f32 v143, v143
    v_cvt_pk_bf16_f32 v158, v140, v141
    v_cvt_pk_bf16_f32 v159, v142, v143
    v_mfma_f32_32x32x16_bf16 v[128:143], a[16:19], v[40:43], 0
    buffer_load_dwordx4 a[112:115], v6, s[4:7], s13 offen offset:0 sc1
    v_exp_f32 v112, v112
    v_exp_f32 v113, v113
    v_exp_f32 v114, v114
    v_exp_f32 v115, v115
    v_cvt_pk_bf16_f32 v144, v112, v113
    v_exp_f32 v116, v116
    v_mfma_f32_32x32x16_bf16 v[128:143], a[20:23], v[44:47], v[128:143]
    buffer_load_dwordx4 a[116:119], v7, s[4:7], s13 offen offset:0 sc1
    v_exp_f32 v117, v117
    v_cvt_pk_bf16_f32 v145, v114, v115
    v_exp_f32 v118, v118
    v_exp_f32 v119, v119
    v_cvt_pk_bf16_f32 v146, v116, v117
    v_exp_f32 v120, v120
    v_mfma_f32_32x32x16_bf16 v[176:191], a[24:27], v[152:155], v[176:191]
    buffer_load_dwordx4 a[120:123], v6, s[4:7], s13 offen offset:2048 sc1
    v_exp_f32 v121, v121
    v_cvt_pk_bf16_f32 v147, v118, v119
    v_exp_f32 v122, v122
    v_exp_f32 v123, v123
    v_cvt_pk_bf16_f32 v148, v120, v121
    v_exp_f32 v124, v124
    v_mfma_f32_32x32x16_bf16 v[176:191], a[28:31], v[156:159], v[176:191]
    s_waitcnt vmcnt(25)
    v_exp_f32 v125, v125
    v_exp_f32 v126, v126
    v_cvt_pk_bf16_f32 v149, v122, v123
    v_exp_f32 v127, v127
    v_cvt_pk_bf16_f32 v150, v124, v125
    v_cvt_pk_bf16_f32 v151, v126, v127
    v_mfma_f32_32x32x16_bf16 v[112:127], a[32:35], v[16:19], 0
    buffer_load_dwordx4 a[124:127], v7, s[4:7], s13 offen offset:2048 sc1
    v_exp_f32 v128, v128
    v_exp_f32 v129, v129
    v_exp_f32 v130, v130
    v_exp_f32 v131, v131
    v_cvt_pk_bf16_f32 v152, v128, v129
    v_exp_f32 v132, v132
    v_mfma_f32_32x32x16_bf16 v[112:127], a[36:39], v[20:23], v[112:127]
    buffer_load_dwordx4 a[144:147], v6, s[4:7], s27 offen offset:0 sc1
    v_exp_f32 v133, v133
    v_cvt_pk_bf16_f32 v153, v130, v131
    v_exp_f32 v134, v134
    v_exp_f32 v135, v135
    v_cvt_pk_bf16_f32 v154, v132, v133
    v_exp_f32 v136, v136
    v_mfma_f32_32x32x16_bf16 v[192:207], a[24:27], v[144:147], v[192:207]
    buffer_load_dword v87, v210, s[4:7], 0 offen sc1
    v_exp_f32 v137, v137
    v_cvt_pk_bf16_f32 v155, v134, v135
    v_exp_f32 v138, v138
    v_exp_f32 v139, v139
    v_cvt_pk_bf16_f32 v156, v136, v137
    v_exp_f32 v140, v140
    v_mfma_f32_32x32x16_bf16 v[192:207], a[28:31], v[148:151], v[192:207]
    buffer_load_dwordx2 v[14:15], v84, s[4:7], s32 offen offset:2560 sc1
    v_exp_f32 v141, v141
    v_exp_f32 v142, v142
    v_cvt_pk_bf16_f32 v157, v138, v139
    v_exp_f32 v143, v143
    s_nop 0
    s_cbranch_execz L_walk
    v_cvt_pk_bf16_f32 v158, v140, v141
    v_cvt_pk_bf16_f32 v159, v142, v143
    v_mfma_f32_32x32x16_bf16 v[128:143], a[32:35], v[24:27], 0
    buffer_load_dwordx4 a[148:151], v7, s[4:7], s27 offen offset:0 sc1
    v_exp_f32 v112, v112
    v_exp_f32 v113, v113
    v_exp_f32 v114, v114
    v_exp_f32 v115, v115
    v_cvt_pk_bf16_f32 v144, v112, v113
    v_exp_f32 v116, v116
    v_mfma_f32_32x32x16_bf16 v[128:143], a[36:39], v[28:31], v[128:143]
    buffer_load_dwordx4 a[152:155], v6, s[4:7], s27 offen offset:2048 sc1
    v_exp_f32 v117, v117
    v_cvt_pk_bf16_f32 v145, v114, v115
    v_exp_f32 v118, v118
    v_exp_f32 v119, v119
    v_cvt_pk_bf16_f32 v146, v116, v117
    v_exp_f32 v120, v120
    v_mfma_f32_32x32x16_bf16 v[48:63], a[24:27], v[152:155], v[48:63]
    buffer_load_dwordx4 a[156:159], v7, s[4:7], s27 offen offset:2048 sc1
    s_add_u32 s27, s27, 4096
    v_exp_f32 v121, v121
    v_cvt_pk_bf16_f32 v147, v118, v119
    v_exp_f32 v122, v122
    v_exp_f32 v123, v123
    v_cvt_pk_bf16_f32 v148, v120, v121
    v_exp_f32 v124, v124
    v_mfma_f32_32x32x16_bf16 v[48:63], a[28:31], v[156:159], v[48:63]
    buffer_load_dwordx4 a[160:163], v6, s[4:7], s27 offen offset:0 sc1
    v_exp_f32 v125, v125
    v_exp_f32 v126, v126
    v_cvt_pk_bf16_f32 v149, v122, v123
    v_exp_f32 v127, v127
    v_cvt_pk_bf16_f32 v150, v124, v125
    v_cvt_pk_bf16_f32 v151, v126, v127
    v_mfma_f32_32x32x16_bf16 v[112:127], a[32:35], v[32:35], 0
    buffer_load_dwordx4 a[164:167], v7, s[4:7], s27 offen offset:0 sc1
    v_exp_f32 v128, v128
    v_exp_f32 v129, v129
    v_exp_f32 v130, v130
    v_exp_f32 v131, v131
    v_cvt_pk_bf16_f32 v152, v128, v129
    v_exp_f32 v132, v132
    v_mfma_f32_32x32x16_bf16 v[112:127], a[36:39], v[36:39], v[112:127]
    buffer_load_dwordx4 a[168:171], v6, s[4:7], s27 offen offset:2048 sc1
    v_exp_f32 v133, v133
    v_cvt_pk_bf16_f32 v153, v130, v131
    v_exp_f32 v134, v134
    v_exp_f32 v135, v135
    v_cvt_pk_bf16_f32 v154, v132, v133
    v_exp_f32 v136, v136
    v_mfma_f32_32x32x16_bf16 v[160:175], a[40:43], v[144:147], v[160:175]
    buffer_load_dwordx4 a[172:175], v7, s[4:7], s27 offen offset:2048 sc1
    s_add_u32 s27, s27, 4096
    v_exp_f32 v137, v137
    v_cvt_pk_bf16_f32 v155, v134, v135
    v_exp_f32 v138, v138
    v_exp_f32 v139, v139
    v_cvt_pk_bf16_f32 v156, v136, v137
    v_exp_f32 v140, v140
    v_mfma_f32_32x32x16_bf16 v[160:175], a[44:47], v[148:151], v[160:175]
    buffer_load_dwordx4 a[176:179], v6, s[4:7], s27 offen offset:0 sc1
    v_exp_f32 v141, v141
    v_exp_f32 v142, v142
    v_cvt_pk_bf16_f32 v157, v138, v139
    v_exp_f32 v143, v143
    v_cvt_pk_bf16_f32 v158, v140, v141
    v_cvt_pk_bf16_f32 v159, v142, v143
    v_mfma_f32_32x32x16_bf16 v[128:143], a[32:35], v[40:43], 0
    buffer_load_dwordx4 a[180:183], v7, s[4:7], s27 offen offset:0 sc1
    v_exp_f32 v112, v112
    v_exp_f32 v113, v113
    v_exp_f32 v114, v114
    v_exp_f32 v115, v115
    v_cvt_pk_bf16_f32 v144, v112, v113
    v_exp_f32 v116, v116
    v_mfma_f32_32x32x16_bf16 v[128:143], a[36:39], v[44:47], v[128:143]
    buffer_load_dwordx4 a[184:187], v6, s[4:7], s27 offen offset:2048 sc1
    v_exp_f32 v117, v117
    v_cvt_pk_bf16_f32 v145, v114, v115
    v_exp_f32 v118, v118
    v_exp_f32 v119, v119
    v_cvt_pk_bf16_f32 v146, v116, v117
    v_exp_f32 v120, v120
    s_cbranch_execz L_walk
    v_mfma_f32_32x32x16_bf16 v[176:191], a[40:43], v[152:155], v[176:191]
    buffer_load_dwordx4 a[188:191], v7, s[4:7], s27 offen offset:2048 sc1
    s_add_u32 s27, s27, 4096
    v_exp_f32 v121, v121
    v_cvt_pk_bf16_f32 v147, v118, v119
    v_exp_f32 v122, v122
    v_exp_f32 v123, v123
    v_cvt_pk_bf16_f32 v148, v120, v121
    v_exp_f32 v124, v124
    v_mfma_f32_32x32x16_bf16 v[176:191], a[44:47], v[156:159], v[176:191]
    s_waitcnt vmcnt(30)
    v_exp_f32 v125, v125
    v_exp_f32 v126, v126
    v_cvt_pk_bf16_f32 v149, v122, v123
    v_exp_f32 v127, v127
    v_cvt_pk_bf16_f32 v150, v124, v125
    v_cvt_pk_bf16_f32 v151, v126, v127
    v_mfma_f32_32x32x16_bf16 v[112:127], a[48:51], v[16:19], 0
    buffer_load_dwordx4 a[192:195], v6, s[4:7], s27 offen offset:0 sc1
    v_exp_f32 v128, v128
    v_exp_f32 v129, v129
    v_exp_f32 v130, v130
    v_exp_f32 v131, v131
    v_cvt_pk_bf16_f32 v152, v128, v129
    v_exp_f32 v132, v132
    v_mfma_f32_32x32x16_bf16 v[112:127], a[52:55], v[20:23], v[112:127]
    buffer_load_dwordx4 a[196:199], v7, s[4:7], s27 offen offset:0 sc1
    v_exp_f32 v133, v133
    v_cvt_pk_bf16_f32 v153, v130, v131
    v_exp_f32 v134, v134
    v_exp_f32 v135, v135
    v_cvt_pk_bf16_f32 v154, v132, v133
    v_exp_f32 v136, v136
    v_mfma_f32_32x32x16_bf16 v[192:207], a[40:43], v[144:147], v[192:207]
    buffer_load_dwordx4 a[200:203], v6, s[4:7], s27 offen offset:2048 sc1
    v_exp_f32 v137, v137
    v_cvt_pk_bf16_f32 v155, v134, v135
    v_exp_f32 v138, v138
    v_exp_f32 v139, v139
    v_cvt_pk_bf16_f32 v156, v136, v137
    v_exp_f32 v140, v140
    v_mfma_f32_32x32x16_bf16 v[192:207], a[44:47], v[148:151], v[192:207]
    buffer_load_dwordx4 a[204:207], v7, s[4:7], s27 offen offset:2048 sc1
    s_add_u32 s27, s27, 4096
    v_exp_f32 v141, v141
    v_exp_f32 v142, v142
    v_cvt_pk_bf16_f32 v157, v138, v139
    v_exp_f32 v143, v143
    v_cvt_pk_bf16_f32 v158, v140, v141
    v_cvt_pk_bf16_f32 v159, v142, v143
    v_mfma_f32_32x32x16_bf16 v[128:143], a[48:51], v[24:27], 0
    buffer_load_dwordx4 a[208:211], v6, s[4:7], s27 offen offset:0 sc1
    v_exp_f32 v112, v112
    v_exp_f32 v113, v113
    v_exp_f32 v114, v114
    v_exp_f32 v115, v115
    v_cvt_pk_bf16_f32 v144, v112, v113
    v_exp_f32 v116, v116
    v_mfma_f32_32x32x16_bf16 v[128:143], a[52:55], v[28:31], v[128:143]
    buffer_load_dwordx4 a[212:215], v7, s[4:7], s27 offen offset:0 sc1
    v_exp_f32 v117, v117
    v_cvt_pk_bf16_f32 v145, v114, v115
    v_exp_f32 v118, v118
    v_exp_f32 v119, v119
    v_cvt_pk_bf16_f32 v146, v116, v117
    v_exp_f32 v120, v120
    v_mfma_f32_32x32x16_bf16 v[48:63], a[40:43], v[152:155], v[48:63]
    buffer_load_dwordx4 a[216:219], v6, s[4:7], s27 offen offset:2048 sc1
    v_exp_f32 v121, v121
    v_cvt_pk_bf16_f32 v147, v118, v119
    v_exp_f32 v122, v122
    v_exp_f32 v123, v123
    v_cvt_pk_bf16_f32 v148, v120, v121
    v_exp_f32 v124, v124
    v_mfma_f32_32x32x16_bf16 v[48:63], a[44:47], v[156:159], v[48:63]
    buffer_load_dwordx4 a[220:223], v7, s[4:7], s27 offen offset:2048 sc1
    s_add_u32 s27, s27, 4096
    v_exp_f32 v125, v125
    v_exp_f32 v126, v126
    v_cvt_pk_bf16_f32 v149, v122, v123
    v_exp_f32 v127, v127
    v_cvt_pk_bf16_f32 v150, v124, v125
    v_cvt_pk_bf16_f32 v151, v126, v127
    s_nop 0
    s_cbranch_execz L_walk
    v_mfma_f32_32x32x16_bf16 v[160:175], a[56:59], v[144:147], v[160:175]
    buffer_load_dwordx4 a[224:227], v6, s[4:7], s27 offen offset:0 sc1
    v_exp_f32 v128, v128
    v_exp_f32 v129, v129
    v_exp_f32 v130, v130
    v_exp_f32 v131, v131
    v_cvt_pk_bf16_f32 v152, v128, v129
    v_exp_f32 v132, v132
    v_mfma_f32_32x32x16_bf16 v[160:175], a[60:63], v[148:151], v[160:175]
    buffer_load_dwordx4 a[228:231], v7, s[4:7], s27 offen offset:0 sc1
    v_exp_f32 v133, v133
    v_cvt_pk_bf16_f32 v153, v130, v131
    v_exp_f32 v134, v134
    v_exp_f32 v135, v135
    v_cvt_pk_bf16_f32 v154, v132, v133
    v_exp_f32 v136, v136
    v_mfma_f32_32x32x16_bf16 v[112:127], a[48:51], v[32:35], 0
    buffer_load_dwordx4 a[232:235], v6, s[4:7], s27 offen offset:2048 sc1
    v_exp_f32 v137, v137
    v_cvt_pk_bf16_f32 v155, v134, v135
    v_exp_f32 v138, v138
    v_exp_f32 v139, v139
    v_cvt_pk_bf16_f32 v156, v136, v137
    v_exp_f32 v140, v140
    v_mfma_f32_32x32x16_bf16 v[112:127], a[52:55], v[36:39], v[112:127]
    buffer_load_dwordx4 a[236:239], v7, s[4:7], s27 offen offset:2048 sc1
    s_add_u32 s27, s27, 4096
    v_exp_f32 v141, v141
    v_exp_f32 v142, v142
    v_cvt_pk_bf16_f32 v157, v138, v139
    v_exp_f32 v143, v143
    v_cvt_pk_bf16_f32 v158, v140, v141
    v_cvt_pk_bf16_f32 v159, v142, v143
    s_nop 3
    v_mfma_f32_32x32x16_bf16 v[176:191], a[56:59], v[152:155], v[176:191]
    ds_write_b128 v11, v[160:163] offset:0
    buffer_load_dwordx4 a[240:243], v6, s[4:7], s27 offen offset:0 sc1
    v_exp_f32 v112, v112
    v_exp_f32 v113, v113
    v_exp_f32 v114, v114
    v_exp_f32 v115, v115
    v_cvt_pk_bf16_f32 v144, v112, v113
    v_exp_f32 v116, v116
    v_mfma_f32_32x32x16_bf16 v[176:191], a[60:63], v[156:159], v[176:191]
    ds_write_b128 v11, v[164:167] offset:1024
    v_exp_f32 v117, v117
    v_cvt_pk_bf16_f32 v145, v114, v115
    v_exp_f32 v118, v118
    v_exp_f32 v119, v119
    v_cvt_pk_bf16_f32 v146, v116, v117
    v_exp_f32 v120, v120
    v_mfma_f32_32x32x16_bf16 v[128:143], a[48:51], v[40:43], 0
    ds_write_b128 v11, v[168:171] offset:2048
    buffer_load_dwordx4 a[244:247], v7, s[4:7], s27 offen offset:0 sc1
    v_exp_f32 v121, v121
    v_cvt_pk_bf16_f32 v147, v118, v119
    v_exp_f32 v122, v122
    v_exp_f32 v123, v123
    v_cvt_pk_bf16_f32 v148, v120, v121
    v_exp_f32 v124, v124
    v_mfma_f32_32x32x16_bf16 v[128:143], a[52:55], v[44:47], v[128:143]
    ds_write_b128 v11, v[172:175] offset:3072
    v_exp_f32 v125, v125
    v_exp_f32 v126, v126
    v_cvt_pk_bf16_f32 v149, v122, v123
    v_exp_f32 v127, v127
    v_cvt_pk_bf16_f32 v150, v124, v125
    v_cvt_pk_bf16_f32 v151, v126, v127
    s_nop 2
    v_mfma_f32_32x32x16_bf16 v[192:207], a[56:59], v[144:147], v[192:207]
    ds_write_b128 v10, v[176:179] offset:0
    buffer_load_dwordx4 a[248:251], v6, s[4:7], s27 offen offset:2048 sc1
    v_exp_f32 v128, v128
    v_exp_f32 v129, v129
    v_exp_f32 v130, v130
    v_exp_f32 v131, v131
    v_cvt_pk_bf16_f32 v152, v128, v129
    v_exp_f32 v132, v132
    v_mfma_f32_32x32x16_bf16 v[192:207], a[60:63], v[148:151], v[192:207]
    ds_write_b128 v10, v[180:183] offset:1024
    v_exp_f32 v133, v133
    v_cvt_pk_bf16_f32 v153, v130, v131
    v_exp_f32 v134, v134
    v_exp_f32 v135, v135
    s_nop 0
    s_cbranch_execz L_walk
    v_cvt_pk_bf16_f32 v154, v132, v133
    v_exp_f32 v136, v136
    ds_write_b128 v10, v[184:187] offset:2048
    buffer_load_dwordx4 a[252:255], v7, s[4:7], s27 offen offset:2048 sc1
    v_exp_f32 v137, v137
    v_cvt_pk_bf16_f32 v155, v134, v135
    v_exp_f32 v138, v138
    v_exp_f32 v139, v139
    v_cvt_pk_bf16_f32 v156, v136, v137
    v_exp_f32 v140, v140
    ds_write_b128 v10, v[188:191] offset:3072
    v_exp_f32 v141, v141
    v_exp_f32 v142, v142
    v_cvt_pk_bf16_f32 v157, v138, v139
    v_exp_f32 v143, v143
    v_cvt_pk_bf16_f32 v158, v140, v141
    v_cvt_pk_bf16_f32 v159, v142, v143
    ds_write_b128 v9, v[192:195] offset:0
    ds_write_b128 v9, v[196:199] offset:1024
    v_mfma_f32_32x32x16_bf16 v[48:63], a[56:59], v[152:155], v[48:63]
    v_mfma_f32_32x32x16_bf16 v[48:63], a[60:63], v[156:159], v[48:63]
    ds_write_b128 v9, v[200:203] offset:2048
    ds_write_b128 v9, v[204:207] offset:3072
    s_branch L_tailr
L_final:
    s_mov_b32 s36, s60
    s_mov_b32 s37, s61
    s_mov_b32 s38, 1835008
    s_mov_b32 s39, 0x20000
    v_and_b32 v14, 31, v1
    v_mul_u32_u24 v14, 896, v14
    v_lshl_add_u32 v14, v5, 4, v14
    s_lshr_b32 s14, s67, 12
    s_mul_i32 s14, s14, 28672
    s_and_b32 s15, s67, 0xf00
    s_lshr_b32 s15, s15, 2
    s_add_u32 s14, s14, s15
    v_permlane32_swap_b32 v80, v82
    v_permlane32_swap_b32 v81, v83
    v_permlane32_swap_b32 v84, v86
    v_permlane32_swap_b32 v85, v87
    buffer_store_dwordx4 v[80:83], v14, s[36:39], s14 offen
    buffer_store_dwordx4 v[84:87], v14, s[36:39], s14 offen offset:32
    s_endpgm
L_tg:
    s_mov_b32 s16, 400000
L_tm:
    buffer_load_dwordx2 v[214:215], off, s[44:47], 0 sc0 sc1
    s_sub_u32 s16, s16, 1
    s_cmp_eq_u32 s16, 0
    s_cbranch_scc1 L_tb
    s_waitcnt vmcnt(0)
    v_readfirstlane_b32 s43, v215
    v_readfirstlane_b32 s42, v214
    s_cmp_eq_u32 s43, 0
    s_cbranch_scc1 L_tm
    s_branch L_tb
L_pl2:
    s_mov_b32 s25, 400000
L_pm2:
    buffer_load_dwordx2 v[14:15], v84, s[4:7], s14 offen sc1
    s_sub_u32 s25, s25, 1
    s_cmp_eq_u32 s25, 0
    s_cbranch_scc1 L_pb2
    s_waitcnt vmcnt(0)
    v_cmp_ne_u64 vcc, s[42:43], v[14:15]
    s_cbranch_vccnz L_pm2
    s_branch L_pb2
L_pf:
    s_lshl_b32 s24, s3, 7
    s_add_u32 s24, s24, s15
    s_lshl_b32 s25, s8, 3
    s_add_u32 s24, s24, s25
    s_mov_b64 exec, 1
    buffer_store_dwordx2 v[214:215], off, s[4:7], s24 sc1
    s_mov_b64 exec, -1
    s_branch L_pfr
L_hs3:
    buffer_store_dwordx4 v[144:147], v2, s[4:7], s65 offen sc1
    buffer_store_dwordx4 v[148:151], v2, s[4:7], s65 offen offset:1024 sc1
    s_branch L_hb3
L_hs4:
    buffer_store_dwordx2 v[214:215], off, s[4:7], s24 offset:0 sc1
    s_branch L_hb4
L_pl5:
    s_mov_b32 s25, 400000
L_pm5:
    buffer_load_dwordx2 v[14:15], v3, s[4:7], s32 offen offset:0 sc1
    s_sub_u32 s25, s25, 1
    s_cmp_eq_u32 s25, 0
    s_cbranch_scc1 L_pb5
    s_waitcnt vmcnt(0)
    v_cmp_ne_u64 vcc, s[42:43], v[14:15]
    s_cbranch_vccnz L_pm5
    s_branch L_pb5
L_hs6:
    buffer_store_dwordx4 v[80:83], v2, s[4:7], s14 offen sc1
    buffer_store_dwordx4 v[84:87], v2, s[4:7], s14 offen offset:1024 sc1
    s_branch L_hb6
L_hs7:
    buffer_store_dword v88, v4, s[4:7], s19 offen sc1
    s_branch L_hb7
    s_nop 0
    s_cbranch_execz L_walk
L_hs8:
    buffer_store_dwordx2 v[214:215], off, s[4:7], s24 offset:512 sc1
    s_branch L_hb8
L_pl9:
    s_mov_b32 s25, 400000
L_pm9:
    buffer_load_dwordx2 v[14:15], v0, s[4:7], s32 offen offset:512 sc1
    s_sub_u32 s25, s25, 1
    s_cmp_eq_u32 s25, 0
    s_cbranch_scc1 L_pb9
    s_waitcnt vmcnt(0)
    v_cmp_ne_u64 vcc, s[42:43], v[14:15]
    s_cbranch_vccnz L_pm9
    s_branch L_pb9
L_hs10:
    buffer_store_dwordx2 v[214:215], off, s[4:7], s24 offset:1024 sc1
    s_branch L_hb10
L_pl11:
    s_mov_b32 s25, 400000
L_pm11:
    buffer_load_dwordx2 v[14:15], v212, s[4:7], s32 offen offset:1024 sc1
    s_sub_u32 s25, s25, 1
    s_cmp_eq_u32 s25, 0
    s_cbranch_scc1 L_pb11
    s_waitcnt vmcnt(0)
    v_cmp_ne_u64 vcc, s[42:43], v[14:15]
    s_cbranch_vccnz L_pm11
    s_branch L_pb11
L_hs12:
    buffer_store_dwordx2 v[214:215], off, s[4:7], s24 offset:1536 sc1
    s_branch L_hb12
L_hs13:
    buffer_store_dwordx2 v[214:215], off, s[4:7], s24 offset:3072 sc1
    s_branch L_hb13
L_pl14:
    s_mov_b32 s25, 400000
L_pm14:
    buffer_load_dwordx2 v[14:15], v212, s[4:7], s32 offen offset:1536 sc1
    s_sub_u32 s25, s25, 1
    s_cmp_eq_u32 s25, 0
    s_cbranch_scc1 L_pb14
    s_waitcnt vmcnt(0)
    v_cmp_ne_u64 vcc, s[42:43], v[14:15]
    s_cbranch_vccnz L_pm14
    s_branch L_pb14
L_pl15:
    s_mov_b32 s25, 400000
L_pm15:
    buffer_load_dwordx2 v[14:15], v212, s[4:7], s32 offen offset:3072 sc1
    s_sub_u32 s25, s25, 1
    s_cmp_eq_u32 s25, 0
    s_cbranch_scc1 L_pb15
    s_waitcnt vmcnt(0)
    v_cmp_ne_u64 vcc, s[42:43], v[14:15]
    s_cbranch_vccnz L_pm15
    s_branch L_pb15
L_hs30:
    buffer_store_dwordx4 v[80:83], v2, s[4:7], s14 offen sc1
    buffer_store_dwordx4 v[84:87], v2, s[4:7], s14 offen offset:1024 sc1
    s_branch L_hb30
L_hs31:
    buffer_store_dword v88, v4, s[4:7], s19 offen sc1
    s_branch L_hb31
L_hs32:
    buffer_store_dwordx2 v[214:215], off, s[4:7], s24 offset:2048 sc1
    s_branch L_hb32
L_pl33:
    s_mov_b32 s25, 400000
L_pm33:
    buffer_load_dwordx2 v[14:15], v0, s[4:7], s1 offen offset:2048 sc1
    s_sub_u32 s25, s25, 1
    s_cmp_eq_u32 s25, 0
    s_cbranch_scc1 L_pb33
    s_waitcnt vmcnt(0)
    v_cmp_ne_u64 vcc, s[42:43], v[14:15]
    s_cbranch_vccnz L_pm33
    s_branch L_pb33
L_pl48:
    s_mov_b32 s25, 400000
L_pm48:
    buffer_load_dwordx2 v[14:15], v85, s[4:7], s15 offen sc1
    buffer_load_dwordx2 v[12:13], v85, s[4:7], s16 offen sc1
    s_sub_u32 s25, s25, 1
    s_cmp_eq_u32 s25, 0
    s_cbranch_scc1 L_pb48
    s_waitcnt vmcnt(0)
    v_cmp_ne_u64 vcc, s[42:43], v[14:15]
    s_cbranch_vccnz L_pm48
    v_cmp_ne_u64 vcc, s[42:43], v[12:13]
    s_cbranch_vccnz L_pm48
    s_branch L_pb48
L_slow:
    s_waitcnt vmcnt(0)
    s_lshl_b32 s19, s55, 18
    s_add_u32 s19, s19, s31
    s_mov_b32 s13, s19
    s_mov_b32 s26, 64
    v_mov_b32 v14, 0xff800000
L_slow1:
    buffer_load_dwordx4 a[0:3], v2, s[4:7], s19 offen sc1
    buffer_load_dwordx4 a[4:7], v2, s[4:7], s19 offen offset:1024 sc1
    s_add_u32 s19, s19, 4096
    s_waitcnt vmcnt(0)
    v_mfma_f32_32x32x16_bf16 v[112:127], a[0:3], v[40:43], 0
    v_mfma_f32_32x32x16_bf16 v[112:127], a[4:7], v[44:47], v[112:127]
    s_nop 11
    v_max3_f32 v14, v112, v113, v14
    v_max3_f32 v14, v114, v115, v14
    v_max3_f32 v14, v116, v117, v14
    v_max3_f32 v14, v118, v119, v14
    v_max3_f32 v14, v120, v121, v14
    v_max3_f32 v14, v122, v123, v14
    v_max3_f32 v14, v124, v125, v14
    s_nop 0
    s_cbranch_execz L_walk
    v_max3_f32 v14, v126, v127, v14
    s_sub_u32 s26, s26, 1
    s_cmp_lg_u32 s26, 0
    s_cbranch_scc1 L_slow1
    v_mov_b32 v15, v14
    s_nop 1
    v_permlane32_swap_b32 v14, v15
    v_max_f32 v14, v14, v15
    s_mov_b32 s19, s13
    s_mov_b32 s26, 64
    v_mov_b32 v48, 0
    v_mov_b32 v49, 0
    v_mov_b32 v50, 0
    v_mov_b32 v51, 0
    v_mov_b32 v52, 0
    v_mov_b32 v53, 0
    v_mov_b32 v54, 0
    v_mov_b32 v55, 0
    v_mov_b32 v56, 0
    v_mov_b32 v57, 0
    v_mov_b32 v58, 0
    v_mov_b32 v59, 0
    v_mov_b32 v60, 0
    v_mov_b32 v61, 0
    v_mov_b32 v62, 0
    v_mov_b32 v63, 0
L_slow2:
    buffer_load_dwordx4 a[0:3], v2, s[4:7], s19 offen offset:0 sc1
    buffer_load_dwordx4 a[4:7], v2, s[4:7], s19 offen offset:1024 sc1
    buffer_load_dwordx4 a[8:11], v2, s[4:7], s19 offen offset:2048 sc1
    buffer_load_dwordx4 a[12:15], v2, s[4:7], s19 offen offset:3072 sc1
    s_add_u32 s19, s19, 4096
    s_waitcnt vmcnt(0)
    v_mfma_f32_32x32x16_bf16 v[112:127], a[0:3], v[40:43], 0
    v_mfma_f32_32x32x16_bf16 v[112:127], a[4:7], v[44:47], v[112:127]
    s_nop 11
    v_sub_f32 v112, v112, v14
    v_sub_f32 v113, v113, v14
    v_sub_f32 v114, v114, v14
    v_sub_f32 v115, v115, v14
    v_sub_f32 v116, v116, v14
    v_sub_f32 v117, v117, v14
    v_sub_f32 v118, v118, v14
    v_sub_f32 v119, v119, v14
    v_sub_f32 v120, v120, v14
    v_sub_f32 v121, v121, v14
    v_sub_f32 v122, v122, v14
    v_sub_f32 v123, v123, v14
    v_sub_f32 v124, v124, v14
    v_sub_f32 v125, v125, v14
    v_sub_f32 v126, v126, v14
    v_sub_f32 v127, v127, v14
    v_exp_f32 v112, v112
    v_exp_f32 v113, v113
    v_exp_f32 v114, v114
    v_exp_f32 v115, v115
    v_exp_f32 v116, v116
    v_exp_f32 v117, v117
    v_exp_f32 v118, v118
    v_exp_f32 v119, v119
    v_exp_f32 v120, v120
    v_exp_f32 v121, v121
    v_exp_f32 v122, v122
    v_exp_f32 v123, v123
    v_exp_f32 v124, v124
    v_exp_f32 v125, v125
    v_exp_f32 v126, v126
    v_exp_f32 v127, v127
    s_nop 0
    v_cvt_pk_bf16_f32 v144, v112, v113
    v_cvt_pk_bf16_f32 v145, v114, v115
    v_cvt_pk_bf16_f32 v146, v116, v117
    v_cvt_pk_bf16_f32 v147, v118, v119
    v_cvt_pk_bf16_f32 v148, v120, v121
    v_cvt_pk_bf16_f32 v149, v122, v123
    v_cvt_pk_bf16_f32 v150, v124, v125
    v_cvt_pk_bf16_f32 v151, v126, v127
    s_nop 1
    v_mfma_f32_32x32x16_bf16 v[48:63], a[8:11], v[144:147], v[48:63]
    v_mfma_f32_32x32x16_bf16 v[48:63], a[12:15], v[148:151], v[48:63]
    s_sub_u32 s26, s26, 1
    s_cmp_lg_u32 s26, 0
    s_cbranch_scc1 L_slow2
    s_nop 11
    v_mov_b32 v12, v60
    v_mov_b32 v13, v60
    s_nop 1
    v_permlane32_swap_b32 v12, v13
    s_branch L_fin
L_end:
    s_endpgm
.section .rodata,"a"
.p2align 6
.amdhsa_kernel interleave_layers__mha_block__dense_activation_relu__prompt_kernel
  .amdhsa_next_free_vgpr 512
  .amdhsa_next_free_sgpr 84
  .amdhsa_accum_offset 256
  .amdhsa_group_segment_fixed_size 0
  .amdhsa_kernarg_size 72
  .amdhsa_user_sgpr_count 2
  .amdhsa_user_sgpr_kernarg_segment_ptr 1
  .amdhsa_system_sgpr_workgroup_id_x 1
.end_amdhsa_kernel
```
